```python
import torch

def _softmax(x, axis=-1):
    return torch.softmax(x, dim=axis)
def _gelu(x):
    return torch.nn.functional.gelu(x, approximate="tanh")
def _silu(x):
    return torch.nn.functional.silu(x)
def _sigmoid(x):
    return torch.sigmoid(x)
def _layernorm(x, axis=-1, eps=1e-5):
    m = x.mean(dim=axis, keepdim=True)
    v = x.var(dim=axis, keepdim=True, unbiased=False)
    return (x - m) / torch.sqrt(v + eps)
def _scatter_add(tgt, idx, src, axis=0):
    return tgt.clone().index_add_(axis, idx, src)
def _segment_sum(src, seg, n):
    out = torch.zeros((n,) + src.shape[1:], dtype=src.dtype)
    return out.index_add_(0, seg, src)
def _pad(x, pw):
    flat = tuple(v for pair in reversed(pw) for v in pair)
    return torch.nn.functional.pad(x, flat)

kernel_name = 'concat_heads__softmax_full_mha__sliding_local_dilated__prompt'

def setup_inputs():

    _w = (lambda a: (lambda t: t.to(torch.bfloat16) if t.is_floating_point() else t)(torch.as_tensor(a)))
    def _A_setup():
        B, S, D = 1, 2048, 512
        return {
            "x": _w((lambda *s: torch.randn(*s, dtype=torch.bfloat16) * 0.2)(B, S, D)),
            "wqkv": _w((lambda *s: torch.randn(*s, dtype=torch.bfloat16) * 0.4)(D, 3 * D)),
            "wo": _w((lambda *s: torch.randn(*s, dtype=torch.bfloat16) * 0.1)(D, D)),
        }
    _A_in = _A_setup()

    def _B_setup():
        B, S, D = 1, 2048, 512
        return {
            "x": _w((lambda *s: torch.randn(*s, dtype=torch.bfloat16) * 0.4)(B, S, D)),
            "wqkv": _w((lambda *s: torch.randn(*s, dtype=torch.bfloat16) * 0.4)(D, 3 * D)),
            "wo": _w((lambda *s: torch.randn(*s, dtype=torch.bfloat16) * 0.05)(D, D)),
        }
    _B_in = _B_setup()

    return {
        "A_x": _A_in["x"],
        "A_wqkv": _A_in["wqkv"],
        "A_wo": _A_in["wo"],
        "B_x": _B_in["x"],
        "B_wqkv": _B_in["wqkv"],
        "B_wo": _B_in["wo"],
    }

def reference(A_x, A_wqkv, A_wo, B_x, B_wqkv, B_wo):
    def _A_ref(x, wqkv, wo):
        B, S, D = x.shape
        H = 32; Dh = D // H
        qkv = (lambda x, *d: x.permute(*d))((x @ wqkv).reshape(B, S, 3, H, Dh), 2, 0, 3, 1, 4)
        q, k, v = qkv[0], qkv[1], qkv[2]
        scale = Dh ** -0.5
        scores = torch.einsum("bhqd,bhkd->bhqk", q, k) * scale
        p = _softmax(scores, axis=-1)
        o = torch.einsum("bhqk,bhkd->bhqd", p, v)
        return (lambda x, *d: x.permute(*d))(o, 0, 2, 1, 3).reshape(B, S, D) @ wo

    def _B_ref(x, wqkv, wo):
        B, S, D = x.shape
        H = 32; Dh = D // H
        W, dil = 8, 2
        qkv = (lambda x, *d: x.permute(*d))((x @ wqkv).reshape(B, S, 3, H, Dh), 2, 0, 3, 1, 4)
        q, k, v = qkv[0], qkv[1], qkv[2]
        scale = Dh ** -0.5
        pos = torch.arange(S)
        off = torch.arange(W) * dil
        idx = pos[:, None] - off[None, :]
        mask = idx >= 0
        idx_c = torch.where(mask, idx, 0).reshape(-1)
        kg = k[:, :, idx_c, :].reshape(B, H, S, W, Dh)
        vg = v[:, :, idx_c, :].reshape(B, H, S, W, Dh)
        logits = torch.einsum("bhsd,bhswd->bhsw", q, kg) * scale
        logits = torch.where(mask[None, None, :, :], logits, -1e9)
        attn = _softmax(logits, axis=-1)
        o = torch.einsum("bhsw,bhswd->bhsd", attn, vg)
        return (lambda x, *d: x.permute(*d))(o, 0, 2, 1, 3).reshape(B, S, D) @ wo

    a = _A_ref(A_x, A_wqkv, A_wo)
    b = _B_ref(B_x, B_wqkv, B_wo)
    return torch.concatenate([a, b], axis=-1)
```

```asm
; @launch grid=(256,1,1) block=(768,1,1) lds=163840
.amdgcn_target "amdgcn-amd-amdhsa--gfx950"
.text
.globl concat_heads__softmax_full_mha__sliding_local_dilated__prompt_kernel
.p2align 8
.type concat_heads__softmax_full_mha__sliding_local_dilated__prompt_kernel,@function
concat_heads__softmax_full_mha__sliding_local_dilated__prompt_kernel:
    s_cmp_ge_u32 s2, 256
    s_cbranch_scc1 L_exit
    s_load_dwordx2 s[24:25], s[0:1], 0
    s_load_dwordx2 s[28:29], s[0:1], 8
    v_lshrrev_b32 v2, 6, v0
    v_and_b32 v1, 63, v0
    v_readfirstlane_b32 s60, v2
    s_and_b32 s62, s2, 3
    s_lshl_b32 s62, s62, 1
    s_bfe_u32 s69, s2, 0x10003
    s_or_b32 s62, s62, s69
    s_xor_b32 s62, s62, 2
    s_and_b32 s61, s2, 4
    s_lshl_b32 s61, s61, 2
    s_lshr_b32 s69, s2, 4
    s_or_b32 s61, s61, s69
    s_bitcmp1_b32 s60, 2
    s_cbranch_scc1 L_loader
    s_cmp_lg_u32 s60, 8
    s_cbranch_scc1 L_nopf
    s_getpc_b64 s[96:97]
L_pc:
    s_lshr_b32 s68, s2, 3
    s_lshl_b32 s68, s68, 10
    v_lshl_add_u32 v2, v1, 4, s68
    v_min_u32 v2, L_code_end - L_pc - 16, v2
    v_mov_b32 v3, s97
    v_add_co_u32 v2, vcc, s96, v2
    s_nop 1
    v_addc_co_u32 v3, vcc, 0, v3, vcc
    global_load_dwordx4 v[164:167], v[2:3], off
L_nopf:
    s_cmp_lt_u32 s60, 4
    s_cbranch_scc1 L_gemm
    s_branch L_spare
L_loader:
    s_and_b32 s67, s60, 3
    s_lshl_b32 s71, s67, 11
    s_lshl_b32 s68, s67, 4
    v_lshrrev_b32 v10, 3, v1
    v_add_u32 v11, s68, v10
    v_and_b32 v12, 7, v1
    v_lshrrev_b32 v13, 4, v1
    v_xor_b32 v14, v12, v13
    v_lshlrev_b32 v14, 4, v14
    v_and_b32 v13, 1, v13
    v_lshlrev_b32 v13, 2, v13
    v_xor_b32 v13, v12, v13
    v_lshlrev_b32 v13, 4, v13
    v_mul_u32_u24 v166, 3072, v11
    s_lshl_b32 s68, s62, 7
    v_add3_u32 v166, v166, v13, s68
    v_add_u32 v167, 23552, v166
    s_lshl_b32 s67, s61, 16
    v_lshl_add_u32 v164, v11, 10, v14
    v_add_u32 v164, s67, v164
    v_xor_b32 v165, 64, v164
    v_add_u32 v165, 7168, v165
    s_lshl_b32 s72, s62, 2
    s_add_u32 s72, s72, s61
    s_lshr_b32 s68, s62, 1
    s_add_u32 s72, s72, s68
    s_and_b32 s72, s72, 7
    s_lshl_b32 s72, s72, 7
    s_mov_b32 s26, 0x200000
    s_mov_b32 s27, 0x00020000
    s_mov_b32 s30, 0x180000
    s_mov_b32 s31, 0x00020000
    s_waitcnt lgkmcnt(0)
    s_add_u32 m0, s71, 0
    s_mov_b32 s73, s72
    s_mul_i32 s74, s73, 1536
    buffer_load_dwordx4 v164, s[24:27], s73 offen lds
    buffer_load_dwordx4 v165, s[24:27], s73 offen offset:1024 lds
    s_add_u32 m0, s71, 65536
    s_add_u32 s67, s74, 1024
    buffer_load_dwordx4 v166, s[28:31], s67 offen lds
    buffer_load_dwordx4 v167, s[28:31], s67 offen offset:1024 lds
    s_add_u32 m0, s71, 73728
    s_add_u32 s67, s74, 2048
    buffer_load_dwordx4 v166, s[28:31], s67 offen lds
    buffer_load_dwordx4 v167, s[28:31], s67 offen offset:1024 lds
    s_add_u32 m0, s71, 8192
    s_add_u32 s73, s72, 128
    s_and_b32 s73, s73, 1023
    s_mul_i32 s74, s73, 1536
    buffer_load_dwordx4 v164, s[24:27], s73 offen lds
    buffer_load_dwordx4 v165, s[24:27], s73 offen offset:1024 lds
    s_add_u32 m0, s71, 122880
    s_add_u32 s67, s74, 1024
    buffer_load_dwordx4 v166, s[28:31], s67 offen lds
    buffer_load_dwordx4 v167, s[28:31], s67 offen offset:1024 lds
    s_add_u32 m0, s71, 131072
    s_add_u32 s67, s74, 2048
    buffer_load_dwordx4 v166, s[28:31], s67 offen lds
    buffer_load_dwordx4 v167, s[28:31], s67 offen offset:1024 lds
    s_call_b64 s[98:99], L_asetup
    s_waitcnt vmcnt(10)
    s_add_u32 m0, s71, 16384
    s_add_u32 s73, s72, 256
    s_and_b32 s73, s73, 1023
    s_mul_i32 s74, s73, 1536
    buffer_load_dwordx4 v164, s[24:27], s73 offen lds
    buffer_load_dwordx4 v165, s[24:27], s73 offen offset:1024 lds
    s_waitcnt vmcnt(10)
    s_add_u32 m0, s71, 139264
    s_add_u32 s67, s74, 1024
    buffer_load_dwordx4 v166, s[28:31], s67 offen lds
    buffer_load_dwordx4 v167, s[28:31], s67 offen offset:1024 lds
    s_waitcnt vmcnt(10)
    s_add_u32 m0, s71, 147456
    s_add_u32 s67, s74, 2048
    buffer_load_dwordx4 v166, s[28:31], s67 offen lds
    buffer_load_dwordx4 v167, s[28:31], s67 offen offset:1024 lds
    s_barrier
    s_waitcnt vmcnt(10)
    s_add_u32 m0, s71, 24576
    s_add_u32 s73, s72, 384
    s_and_b32 s73, s73, 1023
    s_mul_i32 s74, s73, 1536
    buffer_load_dwordx4 v164, s[24:27], s73 offen lds
    buffer_load_dwordx4 v165, s[24:27], s73 offen offset:1024 lds
    s_waitcnt vmcnt(10)
    s_add_u32 m0, s71, 81920
    s_add_u32 s67, s74, 1024
    buffer_load_dwordx4 v166, s[28:31], s67 offen lds
    buffer_load_dwordx4 v167, s[28:31], s67 offen offset:1024 lds
    s_waitcnt vmcnt(10)
    s_add_u32 m0, s71, 90112
    s_add_u32 s67, s74, 2048
    buffer_load_dwordx4 v166, s[28:31], s67 offen lds
    buffer_load_dwordx4 v167, s[28:31], s67 offen offset:1024 lds
    s_barrier
    s_waitcnt vmcnt(10)
    s_add_u32 m0, s71, 32768
    s_add_u32 s73, s72, 512
    s_and_b32 s73, s73, 1023
    s_mul_i32 s74, s73, 1536
    buffer_load_dwordx4 v164, s[24:27], s73 offen lds
    buffer_load_dwordx4 v165, s[24:27], s73 offen offset:1024 lds
    s_waitcnt vmcnt(10)
    s_add_u32 m0, s71, 98304
    s_add_u32 s67, s74, 1024
    buffer_load_dwordx4 v166, s[28:31], s67 offen lds
    buffer_load_dwordx4 v167, s[28:31], s67 offen offset:1024 lds
    s_waitcnt vmcnt(10)
    s_add_u32 m0, s71, 106496
    s_add_u32 s67, s74, 2048
    buffer_load_dwordx4 v166, s[28:31], s67 offen lds
    buffer_load_dwordx4 v167, s[28:31], s67 offen offset:1024 lds
    s_barrier
    s_waitcnt vmcnt(10)
    s_add_u32 m0, s71, 40960
    s_add_u32 s73, s72, 640
    s_and_b32 s73, s73, 1023
    s_mul_i32 s74, s73, 1536
    buffer_load_dwordx4 v164, s[24:27], s73 offen lds
    buffer_load_dwordx4 v165, s[24:27], s73 offen offset:1024 lds
    s_waitcnt vmcnt(10)
    s_add_u32 m0, s71, 114688
    s_add_u32 s67, s74, 1024
    buffer_load_dwordx4 v166, s[28:31], s67 offen lds
    buffer_load_dwordx4 v167, s[28:31], s67 offen offset:1024 lds
    s_waitcnt vmcnt(10)
    s_add_u32 m0, s71, 65536
    s_add_u32 s67, s74, 2048
    buffer_load_dwordx4 v166, s[28:31], s67 offen lds
    buffer_load_dwordx4 v167, s[28:31], s67 offen offset:1024 lds
    s_barrier
    s_waitcnt vmcnt(10)
    s_add_u32 m0, s71, 49152
    s_add_u32 s73, s72, 768
    s_and_b32 s73, s73, 1023
    s_mul_i32 s74, s73, 1536
    buffer_load_dwordx4 v164, s[24:27], s73 offen lds
    buffer_load_dwordx4 v165, s[24:27], s73 offen offset:1024 lds
    s_waitcnt vmcnt(10)
    s_add_u32 m0, s71, 73728
    s_add_u32 s67, s74, 1024
    buffer_load_dwordx4 v166, s[28:31], s67 offen lds
    buffer_load_dwordx4 v167, s[28:31], s67 offen offset:1024 lds
    s_waitcnt vmcnt(10)
    s_add_u32 m0, s71, 122880
    s_add_u32 s67, s74, 2048
    buffer_load_dwordx4 v166, s[28:31], s67 offen lds
    buffer_load_dwordx4 v167, s[28:31], s67 offen offset:1024 lds
    s_barrier
    s_waitcnt vmcnt(10)
    s_add_u32 m0, s71, 57344
    s_add_u32 s73, s72, 896
    s_and_b32 s73, s73, 1023
    s_mul_i32 s74, s73, 1536
    buffer_load_dwordx4 v164, s[24:27], s73 offen lds
    buffer_load_dwordx4 v165, s[24:27], s73 offen offset:1024 lds
    s_waitcnt vmcnt(10)
    s_add_u32 m0, s71, 131072
    s_add_u32 s67, s74, 1024
    buffer_load_dwordx4 v166, s[28:31], s67 offen lds
    buffer_load_dwordx4 v167, s[28:31], s67 offen offset:1024 lds
    s_waitcnt vmcnt(10)
    s_add_u32 m0, s71, 139264
    s_add_u32 s67, s74, 2048
    buffer_load_dwordx4 v166, s[28:31], s67 offen lds
    buffer_load_dwordx4 v167, s[28:31], s67 offen offset:1024 lds
    s_barrier
    s_waitcnt vmcnt(10)
    s_mov_b32 s73, s72
    s_mul_i32 s74, s73, 1536
    s_add_u32 m0, s71, 147456
    s_add_u32 s67, s74, 0
    buffer_load_dwordx4 v166, s[28:31], s67 offen lds
    buffer_load_dwordx4 v167, s[28:31], s67 offen offset:1024 lds
    s_waitcnt vmcnt(10)
    s_add_u32 s73, s72, 128
    s_and_b32 s73, s73, 1023
    s_mul_i32 s74, s73, 1536
    s_add_u32 m0, s71, 81920
    s_add_u32 s67, s74, 0
    buffer_load_dwordx4 v166, s[28:31], s67 offen lds
    buffer_load_dwordx4 v167, s[28:31], s67 offen offset:1024 lds
    s_waitcnt vmcnt(10)
    s_add_u32 s73, s72, 256
    s_and_b32 s73, s73, 1023
    s_mul_i32 s74, s73, 1536
    s_add_u32 m0, s71, 90112
    s_add_u32 s67, s74, 0
    buffer_load_dwordx4 v166, s[28:31], s67 offen lds
    buffer_load_dwordx4 v167, s[28:31], s67 offen offset:1024 lds
    s_barrier
    s_waitcnt vmcnt(10)
    s_add_u32 s73, s72, 384
    s_and_b32 s73, s73, 1023
    s_mul_i32 s74, s73, 1536
    s_add_u32 m0, s71, 98304
    s_add_u32 s67, s74, 0
    buffer_load_dwordx4 v166, s[28:31], s67 offen lds
    buffer_load_dwordx4 v167, s[28:31], s67 offen offset:1024 lds
    s_waitcnt vmcnt(10)
    s_add_u32 s73, s72, 512
    s_and_b32 s73, s73, 1023
    s_mul_i32 s74, s73, 1536
    s_add_u32 m0, s71, 106496
    s_add_u32 s67, s74, 0
    buffer_load_dwordx4 v166, s[28:31], s67 offen lds
    buffer_load_dwordx4 v167, s[28:31], s67 offen offset:1024 lds
    s_waitcnt vmcnt(10)
    s_barrier
    s_add_u32 s73, s72, 640
    s_and_b32 s73, s73, 1023
    s_mul_i32 s74, s73, 1536
    s_add_u32 m0, s71, 65536
    s_add_u32 s67, s74, 0
    buffer_load_dwordx4 v166, s[28:31], s67 offen lds
    buffer_load_dwordx4 v167, s[28:31], s67 offen offset:1024 lds
    s_waitcnt vmcnt(10)
    s_add_u32 s73, s72, 768
    s_and_b32 s73, s73, 1023
    s_mul_i32 s74, s73, 1536
    s_add_u32 m0, s71, 114688
    s_add_u32 s67, s74, 0
    buffer_load_dwordx4 v166, s[28:31], s67 offen lds
    buffer_load_dwordx4 v167, s[28:31], s67 offen offset:1024 lds
    s_waitcnt vmcnt(10)
    s_barrier
    s_add_u32 s73, s72, 896
    s_and_b32 s73, s73, 1023
    s_mul_i32 s74, s73, 1536
    s_add_u32 m0, s71, 73728
    s_add_u32 s67, s74, 0
    buffer_load_dwordx4 v166, s[28:31], s67 offen lds
    buffer_load_dwordx4 v167, s[28:31], s67 offen offset:1024 lds
    s_waitcnt vmcnt(8)
    s_barrier
    s_waitcnt vmcnt(4)
    s_barrier
    s_waitcnt vmcnt(0)
    s_barrier
    s_mov_b32 s85, 194
    s_setprio 2
    s_xor_b32 s77, s77, 8192
    s_add_u32 s67, s84, 4096
    v_lshl_add_u32 v164, v1, 2, s67
    s_add_u32 s67, s78, 4096
    v_lshl_add_u32 v165, v1, 2, s67
    s_add_u32 s67, s79, 4096
    v_lshl_add_u32 v166, v1, 2, s67
    v_and_b32 v167, 12, v5
    v_add_u32 v167, 159744, v167
    s_mov_b32 s82, s76
    s_mov_b32 s83, 0
    s_barrier
    ds_read_b128 v[20:23], v24 offset:0
    ds_read_b128 v[16:19], v25 offset:0
    ds_read_b32 v152, v26 offset:4096
    ds_read_b32 v153, v27 offset:4096
    v_mov_b64 v[154:155], v[24:25]
    s_waitcnt lgkmcnt(0)
    v_max_f32 v7, v152, v153
    v_mov_b32 v24, v7
    v_mov_b32 v25, v7
    v_mov_b64 v[26:27], v[24:25]
    v_mov_b64 v[28:29], v[24:25]
    v_mov_b64 v[30:31], v[24:25]
    v_mov_b64 v[32:33], v[24:25]
    v_mov_b64 v[34:35], v[24:25]
    v_mov_b64 v[36:37], v[24:25]
    v_mov_b64 v[38:39], v[24:25]
    s_mov_b32 s88, 400000
L_1:
    ds_read_b32 v7, v158 offset:0
    s_waitcnt lgkmcnt(0)
    v_cmp_gt_u32 vcc, 1, v7
    s_cbranch_vccz L_2
    s_sub_u32 s88, s88, 1
    s_cmp_lg_u32 s88, 0
    s_cbranch_scc1 L_1
L_2:
    s_sub_u32 m0, s84, 1024
    buffer_load_dwordx4 v[136:139], v3, s[56:59], s82 offen offset:0 sc1
    buffer_load_dwordx4 v3, s[56:59], s82 offen offset:1024 sc1 lds
    buffer_load_dwordx4 v[12:15], v154, s[56:59], s77 offen sc1
    buffer_load_dwordx4 v[8:11], v155, s[56:59], s77 offen sc1
    s_sub_u32 m0, s84, 2048
    buffer_load_dwordx4 v[140:143], v3, s[56:59], s82 offen offset:2048 sc1
    buffer_load_dwordx4 v3, s[56:59], s82 offen offset:3072 sc1 lds
    s_add_u32 s82, s82, 16384
    s_bitset0_b32 s82, 17
    v_mov_b32 v6, 1
    ds_write_b32 v5, v6
    s_mov_b32 s88, 400000
    s_waitcnt vmcnt(2)
L_3:
    v_max3_u32 v7, v8, v9, v10
    v_max3_u32 v7, v7, v11, v12
    v_max3_u32 v7, v7, v13, v14
    v_max_u32 v7, v7, v15
    v_cmp_eq_u32 vcc, -1, v7
    s_cbranch_vccz L_a_go
    s_sub_u32 s88, s88, 1
    s_cmp_eq_u32 s88, 0
    s_cbranch_scc1 L_a_go
    s_sleep 2
    buffer_load_dwordx4 v[12:15], v154, s[56:59], s77 offen sc1
    buffer_load_dwordx4 v[8:11], v155, s[56:59], s77 offen sc1
    s_waitcnt vmcnt(0)
    s_branch L_3
L_handover:
    s_xor_b32 s77, s77, 8192
    s_add_u32 s67, s84, 4096
    v_lshl_add_u32 v164, v1, 2, s67
    s_add_u32 s67, s78, 4096
    v_lshl_add_u32 v165, v1, 2, s67
    s_add_u32 s67, s79, 4096
    v_lshl_add_u32 v166, v1, 2, s67
    v_and_b32 v167, 12, v5
    v_add_u32 v167, 159744, v167
    s_mov_b32 s82, s76
    s_mov_b32 s83, 0
    s_barrier
    ds_read_b128 v[12:15], v24 offset:0
    ds_read_b128 v[8:11], v25 offset:0
    ds_read_b32 v152, v26 offset:4096
    ds_read_b32 v153, v27 offset:4096
    s_cmp_lg_u32 s60, 8
    s_cbranch_scc1 L_5
    s_mov_b32 exec_hi, 0
    s_mov_b32 exec_lo, 255
    buffer_load_dword v6, v159, s[56:59], 0 offen sc1
    s_mov_b64 exec, -1
L_5:
    v_mov_b64 v[154:155], v[24:25]
    s_waitcnt lgkmcnt(0)
    v_max_f32 v7, v152, v153
    v_mov_b32 v24, v7
    v_mov_b32 v25, v7
    v_mov_b64 v[26:27], v[24:25]
    v_mov_b64 v[28:29], v[24:25]
    v_mov_b64 v[30:31], v[24:25]
    v_mov_b64 v[32:33], v[24:25]
    v_mov_b64 v[34:35], v[24:25]
    v_mov_b64 v[36:37], v[24:25]
    v_mov_b64 v[38:39], v[24:25]
    s_cmp_lg_u32 s60, 8
    s_cbranch_scc1 L_6
    s_mov_b64 exec, 0xff
    s_mov_b32 s88, 400000
    s_branch L_pchk_9
L_poll_7:
    buffer_load_dword v6, v159, s[56:59], 0 offen sc1
L_pchk_9:
    s_waitcnt vmcnt(0)
    v_cmp_ne_u32 vcc, 1, v6
    s_cbranch_vccz L_pdone_8
    s_sleep 2
    s_sub_u32 s88, s88, 1
    s_cmp_lg_u32 s88, 0
    s_cbranch_scc1 L_poll_7
L_pdone_8:
    s_mov_b64 exec, -1
    ds_write_b32 v158, v2
L_6:
    s_mov_b32 s88, 400000
L_10:
    ds_read_b32 v7, v158 offset:0
    s_waitcnt lgkmcnt(0)
    v_cmp_gt_u32 vcc, 1, v7
    s_cbranch_vccz L_11
    s_sub_u32 s88, s88, 1
    s_cmp_lg_u32 s88, 0
    s_cbranch_scc1 L_10
L_11:
    s_sub_u32 m0, s84, 1024
    buffer_load_dwordx4 v[136:139], v3, s[56:59], s82 offen offset:0 sc1
    buffer_load_dwordx4 v3, s[56:59], s82 offen offset:1024 sc1 lds
    buffer_load_dwordx4 v[20:23], v154, s[56:59], s77 offen sc1
    buffer_load_dwordx4 v[16:19], v155, s[56:59], s77 offen sc1
    s_sub_u32 m0, s84, 2048
    buffer_load_dwordx4 v[140:143], v3, s[56:59], s82 offen offset:2048 sc1
    buffer_load_dwordx4 v3, s[56:59], s82 offen offset:3072 sc1 lds
    s_add_u32 s82, s82, 16384
    s_bitset0_b32 s82, 17
    v_mov_b32 v6, 1
    ds_write_b32 v5, v6
    s_mov_b32 s88, 400000
    s_waitcnt vmcnt(2)
L_12:
    v_max3_u32 v7, v16, v17, v18
    v_max3_u32 v7, v7, v19, v20
    v_max3_u32 v7, v7, v21, v22
    v_max_u32 v7, v7, v23
    v_cmp_eq_u32 vcc, -1, v7
    s_setprio 1
    s_cbranch_vccz L_a_go
    s_sub_u32 s88, s88, 1
    s_cmp_eq_u32 s88, 0
    s_cbranch_scc1 L_a_go
    s_sleep 2
    buffer_load_dwordx4 v[20:23], v154, s[56:59], s77 offen sc1
    buffer_load_dwordx4 v[16:19], v155, s[56:59], s77 offen sc1
    s_waitcnt vmcnt(0)
    s_branch L_12
L_a_go:
    v_mfma_f32_32x32x16_bf16 v[104:119], v[136:139], v[8:11], v[24:39]
    s_mov_b64 exec, s[80:81]
    ds_read_b128 v[144:147], v4 offset:0
    s_mov_b64 exec, -1
    s_nop 8
.p2align 3
L_loop:
    v_exp_f32 v104, v104
    v_exp_f32 v105, v105
    v_smfmac_f32_32x32x32_bf16 v[88:103], v[148:151], v[128:135], v2
    s_mov_b64 exec, s[80:81]
    ds_read_b128 v[148:151], v4 offset:512
    s_mov_b64 exec, -1
    v_exp_f32 v106, v106
    v_exp_f32 v107, v107
    v_exp_f32 v108, v108
    v_mfma_f32_32x32x16_bf16 v[120:135], v[136:139], v[12:15], v[24:39]
    v_exp_f32 v109, v109
    v_exp_f32 v110, v110
    v_exp_f32 v111, v111
    v_exp_f32 v112, v112
    v_exp_f32 v113, v113
    v_exp_f32 v114, v114
    s_waitcnt lgkmcnt(0)
    v_smfmac_f32_32x32x32_bf16 v[40:55], v[144:147], v[104:111], v2
    v_exp_f32 v115, v115
    v_exp_f32 v116, v116
    v_exp_f32 v117, v117
    v_exp_f32 v118, v118
    v_exp_f32 v119, v119
    v_exp_f32 v120, v120
    v_exp_f32 v121, v121
    v_smfmac_f32_32x32x32_bf16 v[40:55], v[148:151], v[112:119], v2
    v_exp_f32 v122, v122
    v_exp_f32 v123, v123
    v_exp_f32 v124, v124
    v_mfma_f32_32x32x16_bf16 v[104:119], v[136:139], v[16:19], v[24:39]
    v_exp_f32 v125, v125
    v_exp_f32 v126, v126
    v_exp_f32 v127, v127
    v_exp_f32 v128, v128
    v_exp_f32 v129, v129
    v_exp_f32 v130, v130
    v_smfmac_f32_32x32x32_bf16 v[56:71], v[144:147], v[120:127], v2
    v_exp_f32 v131, v131
    v_exp_f32 v132, v132
    v_exp_f32 v133, v133
    v_exp_f32 v134, v134
    v_exp_f32 v135, v135
    v_exp_f32 v104, v104
    v_exp_f32 v105, v105
    v_smfmac_f32_32x32x32_bf16 v[56:71], v[148:151], v[128:135], v2
    v_exp_f32 v106, v106
    v_exp_f32 v107, v107
    v_exp_f32 v108, v108
    v_mfma_f32_32x32x16_bf16 v[120:135], v[136:139], v[20:23], v[24:39]
    s_sub_u32 m0, s84, 1024
    buffer_load_dwordx4 v[136:139], v3, s[56:59], s82 offen offset:0 sc1
    buffer_load_dwordx4 v3, s[56:59], s82 offen offset:1024 sc1 lds
    v_exp_f32 v109, v109
    v_exp_f32 v110, v110
    v_exp_f32 v111, v111
    v_exp_f32 v112, v112
    v_exp_f32 v113, v113
    v_exp_f32 v114, v114
    v_smfmac_f32_32x32x32_bf16 v[72:87], v[144:147], v[104:111], v2
    v_exp_f32 v115, v115
    v_exp_f32 v116, v116
    v_exp_f32 v117, v117
    v_exp_f32 v118, v118
    v_exp_f32 v119, v119
    v_exp_f32 v120, v120
    v_exp_f32 v121, v121
    v_smfmac_f32_32x32x32_bf16 v[72:87], v[148:151], v[112:119], v2
    v_exp_f32 v122, v122
    v_exp_f32 v123, v123
    s_waitcnt vmcnt(2)
    v_exp_f32 v124, v124
    v_mfma_f32_32x32x16_bf16 v[104:119], v[140:143], v[8:11], v[24:39]
    v_exp_f32 v125, v125
    v_exp_f32 v126, v126
    v_exp_f32 v127, v127
    v_exp_f32 v128, v128
    v_exp_f32 v129, v129
    v_exp_f32 v130, v130
    v_smfmac_f32_32x32x32_bf16 v[88:103], v[144:147], v[120:127], v2
    s_mov_b64 exec, s[80:81]
    ds_read_b128 v[144:147], v4 offset:1024
    s_mov_b64 exec, -1
    v_exp_f32 v131, v131
    v_exp_f32 v132, v132
    v_exp_f32 v133, v133
    v_exp_f32 v134, v134
    v_exp_f32 v135, v135
    v_exp_f32 v104, v104
    v_exp_f32 v105, v105
    v_smfmac_f32_32x32x32_bf16 v[88:103], v[148:151], v[128:135], v2
    s_mov_b64 exec, s[80:81]
    ds_read_b128 v[148:151], v4 offset:1536
    s_mov_b64 exec, -1
    v_exp_f32 v106, v106
    v_exp_f32 v107, v107
    v_exp_f32 v108, v108
    v_mfma_f32_32x32x16_bf16 v[120:135], v[140:143], v[12:15], v[24:39]
    v_exp_f32 v109, v109
    v_exp_f32 v110, v110
    v_exp_f32 v111, v111
    v_exp_f32 v112, v112
    v_exp_f32 v113, v113
    v_exp_f32 v114, v114
    s_waitcnt lgkmcnt(0)
    v_smfmac_f32_32x32x32_bf16 v[40:55], v[144:147], v[104:111], v2
    v_exp_f32 v115, v115
    v_exp_f32 v116, v116
    v_exp_f32 v117, v117
    v_exp_f32 v118, v118
    v_exp_f32 v119, v119
    v_exp_f32 v120, v120
    v_exp_f32 v121, v121
    v_smfmac_f32_32x32x32_bf16 v[40:55], v[148:151], v[112:119], v2
    v_exp_f32 v122, v122
    v_exp_f32 v123, v123
    v_exp_f32 v124, v124
    v_mfma_f32_32x32x16_bf16 v[104:119], v[140:143], v[16:19], v[24:39]
    v_exp_f32 v125, v125
    v_exp_f32 v126, v126
    v_exp_f32 v127, v127
    v_exp_f32 v128, v128
    v_exp_f32 v129, v129
    v_exp_f32 v130, v130
    v_smfmac_f32_32x32x32_bf16 v[56:71], v[144:147], v[120:127], v2
    v_exp_f32 v131, v131
    v_exp_f32 v132, v132
    v_exp_f32 v133, v133
    v_exp_f32 v134, v134
    v_exp_f32 v135, v135
    v_exp_f32 v104, v104
    v_exp_f32 v105, v105
    v_smfmac_f32_32x32x32_bf16 v[56:71], v[148:151], v[128:135], v2
    v_exp_f32 v106, v106
    v_exp_f32 v107, v107
    v_exp_f32 v108, v108
    v_mfma_f32_32x32x16_bf16 v[120:135], v[140:143], v[20:23], v[24:39]
    s_sub_u32 m0, s84, 2048
    buffer_load_dwordx4 v[140:143], v3, s[56:59], s82 offen offset:2048 sc1
    buffer_load_dwordx4 v3, s[56:59], s82 offen offset:3072 sc1 lds
    s_add_u32 s82, s82, 16384
    s_bitset0_b32 s82, 17
    v_exp_f32 v109, v109
    v_exp_f32 v110, v110
    v_exp_f32 v111, v111
    v_exp_f32 v112, v112
    v_exp_f32 v113, v113
    v_exp_f32 v114, v114
    v_smfmac_f32_32x32x32_bf16 v[72:87], v[144:147], v[104:111], v2
    v_exp_f32 v115, v115
    v_exp_f32 v116, v116
    v_exp_f32 v117, v117
    v_exp_f32 v118, v118
    v_exp_f32 v119, v119
    v_exp_f32 v120, v120
    v_exp_f32 v121, v121
    v_smfmac_f32_32x32x32_bf16 v[72:87], v[148:151], v[112:119], v2
    v_exp_f32 v122, v122
    v_exp_f32 v123, v123
    s_waitcnt vmcnt(2)
    v_exp_f32 v124, v124
    v_mfma_f32_32x32x16_bf16 v[104:119], v[136:139], v[8:11], v[24:39]
    v_exp_f32 v125, v125
    v_exp_f32 v126, v126
    v_exp_f32 v127, v127
    v_exp_f32 v128, v128
    v_exp_f32 v129, v129
    v_exp_f32 v130, v130
    v_smfmac_f32_32x32x32_bf16 v[88:103], v[144:147], v[120:127], v2
    s_mov_b64 exec, s[80:81]
    ds_read_b128 v[144:147], v4 offset:0
    s_mov_b64 exec, -1
    v_exp_f32 v131, v131
    v_exp_f32 v132, v132
    v_exp_f32 v133, v133
    v_exp_f32 v134, v134
    v_exp_f32 v135, v135
    s_add_u32 s83, s83, 1
    s_bitcmp0_b32 s85, s83
    s_cbranch_scc1 L_loop
    s_cmp_eq_u32 s83, 7
    s_cbranch_scc1 L_last
    s_cmp_eq_u32 s83, 1
    s_cbranch_scc1 L_rest
    s_cmp_ge_u32 s60, 8
    s_cbranch_scc1 L_late
    s_setprio 0
    s_branch L_loop
L_late:
    ds_write_b32 v5, v2 offset:32
    s_branch L_loop
L_rest:
    s_mov_b32 s88, 400000
L_14:
    ds_read_b32 v7, v157 offset:0
    s_waitcnt lgkmcnt(0)
    v_cmp_gt_u32 vcc, 2, v7
    s_cbranch_vccz L_15
    s_sleep 1
    s_sub_u32 s88, s88, 1
    s_cmp_lg_u32 s88, 0
    s_cbranch_scc1 L_14
L_15:
    s_branch L_loop
L_last:
    s_mov_b32 s70, 2
    v_mov_b32 v6, 2
    v_exp_f32 v104, v104
    v_exp_f32 v105, v105
    v_smfmac_f32_32x32x32_bf16 v[88:103], v[148:151], v[128:135], v2
    s_mov_b64 exec, s[80:81]
    ds_read_b128 v[148:151], v4 offset:512
    s_mov_b64 exec, -1
    v_exp_f32 v106, v106
    v_exp_f32 v107, v107
    v_exp_f32 v108, v108
    v_mfma_f32_32x32x16_bf16 v[120:135], v[136:139], v[12:15], v[24:39]
    v_exp_f32 v109, v109
    v_exp_f32 v110, v110
    v_exp_f32 v111, v111
    v_exp_f32 v112, v112
    v_exp_f32 v113, v113
    v_exp_f32 v114, v114
    s_waitcnt lgkmcnt(0)
    v_smfmac_f32_32x32x32_bf16 v[40:55], v[144:147], v[104:111], v2
    v_exp_f32 v115, v115
    v_exp_f32 v116, v116
    v_exp_f32 v117, v117
    v_exp_f32 v118, v118
    v_exp_f32 v119, v119
    v_exp_f32 v120, v120
    v_exp_f32 v121, v121
    v_smfmac_f32_32x32x32_bf16 v[40:55], v[148:151], v[112:119], v2
    v_exp_f32 v122, v122
    v_exp_f32 v123, v123
    v_exp_f32 v124, v124
    v_mfma_f32_32x32x16_bf16 v[104:119], v[136:139], v[16:19], v[24:39]
    v_exp_f32 v125, v125
    v_exp_f32 v126, v126
    v_exp_f32 v127, v127
    v_exp_f32 v128, v128
    v_exp_f32 v129, v129
    v_exp_f32 v130, v130
    v_smfmac_f32_32x32x32_bf16 v[56:71], v[144:147], v[120:127], v2
    v_exp_f32 v131, v131
    v_exp_f32 v132, v132
    v_exp_f32 v133, v133
    v_exp_f32 v134, v134
    v_exp_f32 v135, v135
    v_exp_f32 v104, v104
    v_exp_f32 v105, v105
    v_smfmac_f32_32x32x32_bf16 v[56:71], v[148:151], v[128:135], v2
    v_exp_f32 v106, v106
    v_exp_f32 v107, v107
    v_exp_f32 v108, v108
    v_mfma_f32_32x32x16_bf16 v[120:135], v[136:139], v[20:23], v[24:39]
    v_exp_f32 v109, v109
    v_exp_f32 v110, v110
    v_exp_f32 v111, v111
    v_exp_f32 v112, v112
    v_exp_f32 v113, v113
    v_exp_f32 v114, v114
    v_smfmac_f32_32x32x32_bf16 v[72:87], v[144:147], v[104:111], v2
    v_exp_f32 v115, v115
    v_exp_f32 v116, v116
    v_exp_f32 v117, v117
    v_exp_f32 v118, v118
    v_exp_f32 v119, v119
    v_exp_f32 v120, v120
    v_exp_f32 v121, v121
    v_smfmac_f32_32x32x32_bf16 v[72:87], v[148:151], v[112:119], v2
    v_exp_f32 v122, v122
    v_exp_f32 v123, v123
    s_waitcnt vmcnt(0)
    v_exp_f32 v124, v124
    v_mfma_f32_32x32x16_bf16 v[104:119], v[140:143], v[8:11], v[24:39]
    v_exp_f32 v125, v125
    v_exp_f32 v126, v126
    v_exp_f32 v127, v127
    v_exp_f32 v128, v128
    v_exp_f32 v129, v129
    v_exp_f32 v130, v130
    v_smfmac_f32_32x32x32_bf16 v[88:103], v[144:147], v[120:127], v2
    s_mov_b64 exec, s[80:81]
    ds_read_b128 v[144:147], v4 offset:1024
    s_mov_b64 exec, -1
    v_exp_f32 v131, v131
    v_exp_f32 v132, v132
    v_exp_f32 v133, v133
    v_exp_f32 v134, v134
    v_exp_f32 v135, v135
    v_exp_f32 v104, v104
    v_exp_f32 v105, v105
    v_smfmac_f32_32x32x32_bf16 v[88:103], v[148:151], v[128:135], v2
    s_mov_b64 exec, s[80:81]
    ds_read_b128 v[148:151], v4 offset:1536
    s_mov_b64 exec, -1
    v_exp_f32 v106, v106
    v_exp_f32 v107, v107
    v_exp_f32 v108, v108
    v_mfma_f32_32x32x16_bf16 v[120:135], v[140:143], v[12:15], v[24:39]
    v_exp_f32 v109, v109
    v_exp_f32 v110, v110
    v_exp_f32 v111, v111
    v_exp_f32 v112, v112
    v_exp_f32 v113, v113
    v_exp_f32 v114, v114
    s_waitcnt lgkmcnt(0)
    v_smfmac_f32_32x32x32_bf16 v[40:55], v[144:147], v[104:111], v2
    v_exp_f32 v115, v115
    v_exp_f32 v116, v116
    v_exp_f32 v117, v117
    v_exp_f32 v118, v118
    v_exp_f32 v119, v119
    v_exp_f32 v120, v120
    v_exp_f32 v121, v121
    v_smfmac_f32_32x32x32_bf16 v[40:55], v[148:151], v[112:119], v2
    v_exp_f32 v122, v122
    v_exp_f32 v123, v123
    v_exp_f32 v124, v124
    v_mfma_f32_32x32x16_bf16 v[104:119], v[140:143], v[16:19], v[24:39]
    v_exp_f32 v125, v125
    v_exp_f32 v126, v126
    v_exp_f32 v127, v127
    v_exp_f32 v128, v128
    v_exp_f32 v129, v129
    v_exp_f32 v130, v130
    v_smfmac_f32_32x32x32_bf16 v[56:71], v[144:147], v[120:127], v2
    v_exp_f32 v131, v131
    v_exp_f32 v132, v132
    ds_write_b128 v160, v[40:43] offset:0
    ds_write_b128 v160, v[44:47] offset:1024
    ds_write_b32 v164, v48 offset:0
    v_exp_f32 v133, v133
    v_exp_f32 v134, v134
    v_exp_f32 v135, v135
    s_setprio 0
    v_exp_f32 v104, v104
    v_exp_f32 v105, v105
    v_smfmac_f32_32x32x32_bf16 v[56:71], v[148:151], v[128:135], v2
    v_exp_f32 v106, v106
    v_exp_f32 v107, v107
    v_exp_f32 v108, v108
    v_mfma_f32_32x32x16_bf16 v[120:135], v[140:143], v[20:23], v[24:39]
    v_exp_f32 v109, v109
    v_exp_f32 v110, v110
    v_exp_f32 v111, v111
    v_exp_f32 v112, v112
    v_exp_f32 v113, v113
    v_exp_f32 v114, v114
    v_smfmac_f32_32x32x32_bf16 v[72:87], v[144:147], v[104:111], v2
    v_exp_f32 v115, v115
    v_exp_f32 v116, v116
    ds_write_b128 v160, v[56:59] offset:2048
    ds_write_b128 v160, v[60:63] offset:3072
    ds_write_b32 v164, v64 offset:256
    v_exp_f32 v117, v117
    v_exp_f32 v118, v118
    v_exp_f32 v119, v119
    v_exp_f32 v120, v120
    v_exp_f32 v121, v121
    v_smfmac_f32_32x32x32_bf16 v[72:87], v[148:151], v[112:119], v2
    s_waitcnt lgkmcnt(0)
    ds_write_b32 v5, v6
    ds_read_b32 v7, v167
    ds_read_b32 v138, v163
    ds_read_b128 v[104:107], v161 offset:0
    ds_read_b128 v[108:111], v161 offset:1024
    ds_read_b128 v[112:115], v161 offset:2048
    ds_read_b128 v[116:119], v161 offset:3072
    ds_read2_b32 v[136:137], v165 offset0:0 offset1:64
    v_exp_f32 v122, v122
    v_exp_f32 v123, v123
    v_exp_f32 v124, v124
    v_exp_f32 v125, v125
    v_exp_f32 v126, v126
    v_exp_f32 v127, v127
    v_exp_f32 v128, v128
    v_exp_f32 v129, v129
    v_exp_f32 v130, v130
    v_smfmac_f32_32x32x32_bf16 v[88:103], v[144:147], v[120:127], v2
    v_exp_f32 v131, v131
    v_exp_f32 v132, v132
    s_setprio 3
    v_exp_f32 v133, v133
    v_exp_f32 v134, v134
    v_exp_f32 v135, v135
L_combine:
    s_add_u32 s68, s70, 1
    s_waitcnt lgkmcnt(0)
    v_smfmac_f32_32x32x32_bf16 v[88:103], v[148:151], v[128:135], v2
    v_cmp_gt_u32 vcc, s70, v138
    s_nop 0
    s_bitcmp0_b32 vcc_lo, 2
    s_cbranch_scc1 L_16
    s_mov_b64 exec, 4
    s_mov_b32 s88, 400000
L_17:
    ds_read_b32 v138, v163 offset:0
    s_waitcnt lgkmcnt(0)
    v_cmp_gt_u32 vcc, s70, v138
    s_cbranch_vccz L_18
    s_sub_u32 s88, s88, 1
    s_cmp_lg_u32 s88, 0
    s_cbranch_scc1 L_17
L_18:
    s_mov_b64 exec, -1
    ds_read_b128 v[104:107], v161 offset:0
    ds_read_b128 v[108:111], v161 offset:1024
    ds_read_b128 v[112:115], v161 offset:2048
    ds_read_b128 v[116:119], v161 offset:3072
    ds_read2_b32 v[136:137], v165 offset0:0 offset1:64
    s_waitcnt lgkmcnt(0)
L_16:
    v_add_f32 v72, v72, v104
    v_add_f32 v73, v73, v105
    v_add_f32 v74, v74, v106
    v_add_f32 v75, v75, v107
    v_add_f32 v76, v76, v108
    v_add_f32 v77, v77, v109
    v_add_f32 v78, v78, v110
    v_add_f32 v79, v79, v111
    v_add_f32 v80, v80, v136
    ds_write_b128 v161, v[72:75] offset:0
    ds_write_b128 v161, v[76:79] offset:1024
    ds_write_b32 v165, v80 offset:0
    v_mov_b32 v6, s68
    s_mov_b32 s69, 0x7b800000
    v_add_f32 v88, v88, v112
    v_add_f32 v89, v89, v113
    v_add_f32 v90, v90, v114
    v_add_f32 v91, v91, v115
    v_add_f32 v92, v92, v116
    v_add_f32 v93, v93, v117
    v_add_f32 v94, v94, v118
    v_add_f32 v95, v95, v119
    v_add_f32 v96, v96, v137
    s_waitcnt lgkmcnt(0)
    ds_write_b32 v5, v6
    ds_read_b32 v138, v163
    ds_read_b128 v[24:27], v162
    ds_read_b128 v[28:31], v162 offset:1024
    ds_read_b32 v32, v166
    v_cmp_gt_u32 vcc, 17, v7
    s_cbranch_vccz L_20
    s_mov_b32 s88, 400000
L_19:
    ds_read_b32 v7, v167 offset:0
    s_waitcnt lgkmcnt(0)
    v_cmp_gt_u32 vcc, 17, v7
    s_cbranch_vccz L_20
    s_sub_u32 s88, s88, 1
    s_cmp_lg_u32 s88, 0
    s_cbranch_scc1 L_19
L_20:
    s_waitcnt lgkmcnt(0)
    v_cmp_gt_u32 vcc, s68, v138
    s_nop 0
    s_bitcmp0_b32 vcc_lo, 1
    s_cbranch_scc1 L_21
    s_mov_b64 exec, 2
    s_mov_b32 s88, 400000
L_22:
    ds_read_b32 v138, v163 offset:0
    s_waitcnt lgkmcnt(0)
    v_cmp_gt_u32 vcc, s68, v138
    s_cbranch_vccz L_23
    s_sub_u32 s88, s88, 1
    s_cmp_lg_u32 s88, 0
    s_cbranch_scc1 L_22
L_23:
    s_mov_b64 exec, -1
    ds_read_b128 v[24:27], v162
    ds_read_b128 v[28:31], v162 offset:1024
    ds_read_b32 v32, v166
    s_waitcnt lgkmcnt(0)
L_21:
    v_add_f32 v32, v32, v96
    v_add_f32 v24, v24, v88
    v_add_f32 v25, v25, v89
    v_add_f32 v26, v26, v90
    v_add_f32 v27, v27, v91
    v_add_f32 v28, v28, v92
    v_add_f32 v29, v29, v93
    v_add_f32 v30, v30, v94
    v_add_f32 v31, v31, v95
    v_rcp_f32 v33, v32
    v_max3_f32 v6, |v24|, |v25|, |v26|
    v_max3_f32 v7, |v27|, |v28|, |v29|
    v_max3_f32 v6, v6, |v30|, |v31|
    v_max_f32 v6, v6, v7
    v_mul_f32 v6, 0x3c800000, v6
    v_mul_f32 v7, 0x5d800000, v33
    v_max3_f32 v6, v6, v7, v32
    v_cmp_nlt_f32 vcc, v6, s69
    s_cbranch_vccnz L_unsafe
    s_cmp_eq_u32 s87, 2
    s_cbranch_scc1 L_stored
L_store:
    v_mul_f32 v24, v24, v33
    v_mul_f32 v25, v25, v33
    v_mul_f32 v26, v26, v33
    v_mul_f32 v27, v27, v33
    v_mul_f32 v28, v28, v33
    v_mul_f32 v29, v29, v33
    v_mul_f32 v30, v30, v33
    v_mul_f32 v31, v31, v33
    v_cvt_pk_bf16_f32 v36, v24, v25
    v_cvt_pk_bf16_f32 v37, v26, v27
    v_cvt_pk_bf16_f32 v38, v28, v29
    v_cvt_pk_bf16_f32 v39, v30, v31
    v_min_u32 v36, -2, v36
    v_min_u32 v37, -2, v37
    v_min_u32 v38, -2, v38
    v_min_u32 v39, -2, v39
    buffer_store_dwordx4 v[36:39], v156, s[56:59], s64 offen sc1
    s_cmp_lg_u32 s87, 0
    s_cbranch_scc1 L_stored
    v_mov_b32 v6, 4
L_verdict:
    ds_write_b32 v5, v6
    s_mov_b32 s88, 400000
L_24:
    ds_read_b32 v138, v163 offset:0
    s_waitcnt lgkmcnt(0)
    v_cmp_gt_u32 vcc, 4, v138
    s_cbranch_vccz L_25
    s_sub_u32 s88, s88, 1
    s_cmp_lg_u32 s88, 0
    s_cbranch_scc1 L_24
L_25:
    v_cmp_lt_u32 vcc, 4, v138
    s_cbranch_vccnz L_fallback
L_stored:
    s_barrier
    s_barrier
    s_branch L_end
L_unsafe:
    s_cmp_lg_u32 s87, 0
    s_cbranch_scc1 L_store
    v_mov_b32 v6, 5
    s_branch L_verdict
L_fallback:
    v_readfirstlane_b32 s87, v6
    s_nop 3
    s_sub_u32 s87, 6, s87
    s_bfe_u32 s82, s76, 0x2000c
    s_lshl_b32 s82, s82, 15
    v_mov_b32 v152, 0xff800000
    v_mov_b32 v153, 0xff800000
    v_mov_b32 v154, 0xff800000
    v_mov_b32 v155, 0xff800000
L_fb_loop:
    buffer_load_dwordx4 v[136:139], v3, s[56:59], s82 offen sc1
    s_waitcnt vmcnt(0)
    v_mfma_f32_32x32x16_bf16 v[40:55], v[136:139], v[8:11], 0
    v_mfma_f32_32x32x16_bf16 v[56:71], v[136:139], v[12:15], 0
    v_mfma_f32_32x32x16_bf16 v[72:87], v[136:139], v[16:19], 0
    v_mfma_f32_32x32x16_bf16 v[88:103], v[136:139], v[20:23], 0
    s_nop 15
    v_max3_f32 v152, v152, v40, v41
    v_max3_f32 v152, v152, v42, v43
    v_max3_f32 v152, v152, v44, v45
    v_max3_f32 v152, v152, v46, v47
    v_max3_f32 v152, v152, v48, v49
    v_max3_f32 v152, v152, v50, v51
    v_max3_f32 v152, v152, v52, v53
    v_max3_f32 v152, v152, v54, v55
    v_max3_f32 v153, v153, v56, v57
    v_max3_f32 v153, v153, v58, v59
    v_max3_f32 v153, v153, v60, v61
    v_max3_f32 v153, v153, v62, v63
    v_max3_f32 v153, v153, v64, v65
    v_max3_f32 v153, v153, v66, v67
    v_max3_f32 v153, v153, v68, v69
    v_max3_f32 v153, v153, v70, v71
    v_max3_f32 v154, v154, v72, v73
    v_max3_f32 v154, v154, v74, v75
    v_max3_f32 v154, v154, v76, v77
    v_max3_f32 v154, v154, v78, v79
    v_max3_f32 v154, v154, v80, v81
    v_max3_f32 v154, v154, v82, v83
    v_max3_f32 v154, v154, v84, v85
    v_max3_f32 v154, v154, v86, v87
    v_max3_f32 v155, v155, v88, v89
    v_max3_f32 v155, v155, v90, v91
    v_max3_f32 v155, v155, v92, v93
    v_max3_f32 v155, v155, v94, v95
    v_max3_f32 v155, v155, v96, v97
    v_max3_f32 v155, v155, v98, v99
    v_max3_f32 v155, v155, v100, v101
    v_max3_f32 v155, v155, v102, v103
    s_add_u32 s82, s82, 2048
    s_and_b32 s67, s82, 0x7fff
    s_cbranch_scc1 L_fb_loop
    v_mov_b32 v24, v152
    v_mov_b32 v25, v153
    v_mov_b32 v26, v154
    v_mov_b32 v27, v155
    s_nop 1
    v_permlane32_swap_b32 v152, v24
    v_permlane32_swap_b32 v153, v25
    v_permlane32_swap_b32 v154, v26
    v_permlane32_swap_b32 v155, v27
    s_nop 1
    v_max_f32 v152, v152, v24
    v_max_f32 v153, v153, v25
    v_max_f32 v154, v154, v26
    v_max_f32 v155, v155, v27
    ds_write_b128 v160, v[152:155] offset:2048
    s_sub_u32 s67, s60, 4
    s_xor_b32 s67, s67, 1
    s_mul_i32 s67, s67, 4608
    s_add_u32 s67, s67, 122880
    v_add_u32 v7, s67, v156
    v_mov_b32 v6, 6
    s_waitcnt lgkmcnt(0)
    ds_write_b32 v5, v6
    s_mov_b32 s88, 400000
L_26:
    ds_read_b32 v138, v163 offset:0
    s_waitcnt lgkmcnt(0)
    v_cmp_gt_u32 vcc, 6, v138
    s_cbranch_vccz L_27
    s_sub_u32 s88, s88, 1
    s_cmp_lg_u32 s88, 0
    s_cbranch_scc1 L_26
L_27:
    ds_read_b128 v[24:27], v7 offset:2048
    ds_read_b128 v[28:31], v161 offset:2048
    ds_read_b128 v[32:35], v162 offset:2048
    s_waitcnt lgkmcnt(0)
    v_max3_f32 v152, v152, v25, v30
    v_max_f32 v152, v152, v35
    v_sub_f32 v152, 0, v152
    v_max3_f32 v153, v153, v24, v31
    v_max_f32 v153, v153, v34
    v_sub_f32 v153, 0, v153
    v_max3_f32 v154, v154, v27, v28
    v_max_f32 v154, v154, v33
    v_sub_f32 v154, 0, v154
    v_max3_f32 v155, v155, v26, v29
    v_max_f32 v155, v155, v32
    v_sub_f32 v155, 0, v155
    v_mov_b64 v[50:51], 0
    v_mov_b64 v[52:53], 0
    v_mov_b64 v[54:55], 0
    v_mov_b64 v[66:67], 0
    v_mov_b64 v[68:69], 0
    v_mov_b64 v[70:71], 0
    v_mov_b64 v[82:83], 0
    v_mov_b64 v[84:85], 0
    v_mov_b64 v[86:87], 0
    v_mov_b64 v[98:99], 0
    v_mov_b64 v[100:101], 0
    v_mov_b64 v[102:103], 0
    v_mov_b64 v[40:41], 0
    v_mov_b64 v[42:43], 0
    v_mov_b64 v[44:45], 0
    v_mov_b64 v[46:47], 0
    v_mov_b64 v[48:49], 0
    v_mov_b64 v[56:57], 0
    v_mov_b64 v[58:59], 0
    v_mov_b64 v[60:61], 0
    v_mov_b64 v[62:63], 0
    v_mov_b64 v[64:65], 0
    v_mov_b64 v[72:73], 0
    v_mov_b64 v[74:75], 0
    v_mov_b64 v[76:77], 0
    v_mov_b64 v[78:79], 0
    v_mov_b64 v[80:81], 0
    v_mov_b64 v[88:89], 0
    v_mov_b64 v[90:91], 0
    v_mov_b64 v[92:93], 0
    v_mov_b64 v[94:95], 0
    v_mov_b64 v[96:97], 0
    v_mov_b64 v[128:129], 0
    v_mov_b64 v[130:131], 0
    v_mov_b64 v[132:133], 0
    v_mov_b64 v[134:135], 0
    s_mov_b32 s82, s76
    s_mov_b32 s83, 0
    s_sub_u32 m0, s84, 1024
    buffer_load_dwordx4 v[136:139], v3, s[56:59], s82 offen offset:0 sc1
    buffer_load_dwordx4 v3, s[56:59], s82 offen offset:1024 sc1 lds
    s_sub_u32 m0, s84, 2048
    buffer_load_dwordx4 v[140:143], v3, s[56:59], s82 offen offset:2048 sc1
    buffer_load_dwordx4 v3, s[56:59], s82 offen offset:3072 sc1 lds
    s_add_u32 s82, s82, 16384
    s_bitset0_b32 s82, 17
    v_mov_b32 v24, v152
    v_mov_b32 v25, v152
    v_mov_b64 v[26:27], v[24:25]
    v_mov_b64 v[28:29], v[24:25]
    v_mov_b64 v[30:31], v[24:25]
    v_mov_b64 v[32:33], v[24:25]
    v_mov_b64 v[34:35], v[24:25]
    v_mov_b64 v[36:37], v[24:25]
    v_mov_b64 v[38:39], v[24:25]
    s_waitcnt vmcnt(2)
    s_nop 0
    v_mfma_f32_32x32x16_bf16 v[104:119], v[136:139], v[8:11], v[24:39]
    s_mov_b64 exec, s[80:81]
    ds_read_b128 v[144:147], v4 offset:0
    s_mov_b64 exec, -1
    s_nop 8
L_fb_pass:
    v_exp_f32 v104, v104
    v_exp_f32 v105, v105
    v_smfmac_f32_32x32x32_bf16 v[88:103], v[148:151], v[128:135], v2
    s_mov_b64 exec, s[80:81]
    ds_read_b128 v[148:151], v4 offset:512
    s_mov_b64 exec, -1
    v_mov_b32 v24, v153
    v_mov_b32 v25, v153
    v_mov_b64 v[26:27], v[24:25]
    v_mov_b64 v[28:29], v[24:25]
    v_mov_b64 v[30:31], v[24:25]
    v_mov_b64 v[32:33], v[24:25]
    v_mov_b64 v[34:35], v[24:25]
    v_mov_b64 v[36:37], v[24:25]
    v_mov_b64 v[38:39], v[24:25]
    v_exp_f32 v106, v106
    v_exp_f32 v107, v107
    v_exp_f32 v108, v108
    v_mfma_f32_32x32x16_bf16 v[120:135], v[136:139], v[12:15], v[24:39]
    v_exp_f32 v109, v109
    v_exp_f32 v110, v110
    v_exp_f32 v111, v111
    v_exp_f32 v112, v112
    v_exp_f32 v113, v113
    v_exp_f32 v114, v114
    s_waitcnt lgkmcnt(0)
    v_smfmac_f32_32x32x32_bf16 v[40:55], v[144:147], v[104:111], v2
    v_exp_f32 v115, v115
    v_exp_f32 v116, v116
    v_exp_f32 v117, v117
    v_exp_f32 v118, v118
    v_exp_f32 v119, v119
    v_exp_f32 v120, v120
    v_exp_f32 v121, v121
    v_smfmac_f32_32x32x32_bf16 v[40:55], v[148:151], v[112:119], v2
    v_mov_b32 v24, v154
    v_mov_b32 v25, v154
    v_mov_b64 v[26:27], v[24:25]
    v_mov_b64 v[28:29], v[24:25]
    v_mov_b64 v[30:31], v[24:25]
    v_mov_b64 v[32:33], v[24:25]
    v_mov_b64 v[34:35], v[24:25]
    v_mov_b64 v[36:37], v[24:25]
    v_mov_b64 v[38:39], v[24:25]
    v_exp_f32 v122, v122
    v_exp_f32 v123, v123
    v_exp_f32 v124, v124
    v_mfma_f32_32x32x16_bf16 v[104:119], v[136:139], v[16:19], v[24:39]
    v_exp_f32 v125, v125
    v_exp_f32 v126, v126
    v_exp_f32 v127, v127
    v_exp_f32 v128, v128
    v_exp_f32 v129, v129
    v_exp_f32 v130, v130
    v_smfmac_f32_32x32x32_bf16 v[56:71], v[144:147], v[120:127], v2
    v_exp_f32 v131, v131
    v_exp_f32 v132, v132
    v_exp_f32 v133, v133
    v_exp_f32 v134, v134
    v_exp_f32 v135, v135
    v_exp_f32 v104, v104
    v_exp_f32 v105, v105
    v_smfmac_f32_32x32x32_bf16 v[56:71], v[148:151], v[128:135], v2
    v_mov_b32 v24, v155
    v_mov_b32 v25, v155
    v_mov_b64 v[26:27], v[24:25]
    v_mov_b64 v[28:29], v[24:25]
    v_mov_b64 v[30:31], v[24:25]
    v_mov_b64 v[32:33], v[24:25]
    v_mov_b64 v[34:35], v[24:25]
    v_mov_b64 v[36:37], v[24:25]
    v_mov_b64 v[38:39], v[24:25]
    v_exp_f32 v106, v106
    v_exp_f32 v107, v107
    v_exp_f32 v108, v108
    v_mfma_f32_32x32x16_bf16 v[120:135], v[136:139], v[20:23], v[24:39]
    s_sub_u32 m0, s84, 1024
    buffer_load_dwordx4 v[136:139], v3, s[56:59], s82 offen offset:0 sc1
    buffer_load_dwordx4 v3, s[56:59], s82 offen offset:1024 sc1 lds
    v_exp_f32 v109, v109
    v_exp_f32 v110, v110
    v_exp_f32 v111, v111
    v_exp_f32 v112, v112
    v_exp_f32 v113, v113
    v_exp_f32 v114, v114
    v_smfmac_f32_32x32x32_bf16 v[72:87], v[144:147], v[104:111], v2
    v_exp_f32 v115, v115
    v_exp_f32 v116, v116
    v_exp_f32 v117, v117
    v_exp_f32 v118, v118
    v_exp_f32 v119, v119
    v_exp_f32 v120, v120
    v_exp_f32 v121, v121
    v_smfmac_f32_32x32x32_bf16 v[72:87], v[148:151], v[112:119], v2
    v_mov_b32 v24, v152
    v_mov_b32 v25, v152
    v_mov_b64 v[26:27], v[24:25]
    v_mov_b64 v[28:29], v[24:25]
    v_mov_b64 v[30:31], v[24:25]
    v_mov_b64 v[32:33], v[24:25]
    v_mov_b64 v[34:35], v[24:25]
    v_mov_b64 v[36:37], v[24:25]
    v_mov_b64 v[38:39], v[24:25]
    v_exp_f32 v122, v122
    v_exp_f32 v123, v123
    s_waitcnt vmcnt(2)
    v_exp_f32 v124, v124
    v_mfma_f32_32x32x16_bf16 v[104:119], v[140:143], v[8:11], v[24:39]
    v_exp_f32 v125, v125
    v_exp_f32 v126, v126
    v_exp_f32 v127, v127
    v_exp_f32 v128, v128
    v_exp_f32 v129, v129
    v_exp_f32 v130, v130
    v_smfmac_f32_32x32x32_bf16 v[88:103], v[144:147], v[120:127], v2
    s_mov_b64 exec, s[80:81]
    ds_read_b128 v[144:147], v4 offset:1024
    s_mov_b64 exec, -1
    v_exp_f32 v131, v131
    v_exp_f32 v132, v132
    v_exp_f32 v133, v133
    v_exp_f32 v134, v134
    v_exp_f32 v135, v135
    v_exp_f32 v104, v104
    v_exp_f32 v105, v105
    v_smfmac_f32_32x32x32_bf16 v[88:103], v[148:151], v[128:135], v2
    s_mov_b64 exec, s[80:81]
    ds_read_b128 v[148:151], v4 offset:1536
    s_mov_b64 exec, -1
    v_mov_b32 v24, v153
    v_mov_b32 v25, v153
    v_mov_b64 v[26:27], v[24:25]
    v_mov_b64 v[28:29], v[24:25]
    v_mov_b64 v[30:31], v[24:25]
    v_mov_b64 v[32:33], v[24:25]
    v_mov_b64 v[34:35], v[24:25]
    v_mov_b64 v[36:37], v[24:25]
    v_mov_b64 v[38:39], v[24:25]
    v_exp_f32 v106, v106
    v_exp_f32 v107, v107
    v_exp_f32 v108, v108
    v_mfma_f32_32x32x16_bf16 v[120:135], v[140:143], v[12:15], v[24:39]
    v_exp_f32 v109, v109
    v_exp_f32 v110, v110
    v_exp_f32 v111, v111
    v_exp_f32 v112, v112
    v_exp_f32 v113, v113
    v_exp_f32 v114, v114
    s_waitcnt lgkmcnt(0)
    v_smfmac_f32_32x32x32_bf16 v[40:55], v[144:147], v[104:111], v2
    v_exp_f32 v115, v115
    v_exp_f32 v116, v116
    v_exp_f32 v117, v117
    v_exp_f32 v118, v118
    v_exp_f32 v119, v119
    v_exp_f32 v120, v120
    v_exp_f32 v121, v121
    v_smfmac_f32_32x32x32_bf16 v[40:55], v[148:151], v[112:119], v2
    v_mov_b32 v24, v154
    v_mov_b32 v25, v154
    v_mov_b64 v[26:27], v[24:25]
    v_mov_b64 v[28:29], v[24:25]
    v_mov_b64 v[30:31], v[24:25]
    v_mov_b64 v[32:33], v[24:25]
    v_mov_b64 v[34:35], v[24:25]
    v_mov_b64 v[36:37], v[24:25]
    v_mov_b64 v[38:39], v[24:25]
    v_exp_f32 v122, v122
    v_exp_f32 v123, v123
    v_exp_f32 v124, v124
    v_mfma_f32_32x32x16_bf16 v[104:119], v[140:143], v[16:19], v[24:39]
    v_exp_f32 v125, v125
    v_exp_f32 v126, v126
    v_exp_f32 v127, v127
    v_exp_f32 v128, v128
    v_exp_f32 v129, v129
    v_exp_f32 v130, v130
    v_smfmac_f32_32x32x32_bf16 v[56:71], v[144:147], v[120:127], v2
    v_exp_f32 v131, v131
    v_exp_f32 v132, v132
    v_exp_f32 v133, v133
    v_exp_f32 v134, v134
    v_exp_f32 v135, v135
    v_exp_f32 v104, v104
    v_exp_f32 v105, v105
    v_smfmac_f32_32x32x32_bf16 v[56:71], v[148:151], v[128:135], v2
    v_mov_b32 v24, v155
    v_mov_b32 v25, v155
    v_mov_b64 v[26:27], v[24:25]
    v_mov_b64 v[28:29], v[24:25]
    v_mov_b64 v[30:31], v[24:25]
    v_mov_b64 v[32:33], v[24:25]
    v_mov_b64 v[34:35], v[24:25]
    v_mov_b64 v[36:37], v[24:25]
    v_mov_b64 v[38:39], v[24:25]
    v_exp_f32 v106, v106
    v_exp_f32 v107, v107
    v_exp_f32 v108, v108
    v_mfma_f32_32x32x16_bf16 v[120:135], v[140:143], v[20:23], v[24:39]
    s_sub_u32 m0, s84, 2048
    buffer_load_dwordx4 v[140:143], v3, s[56:59], s82 offen offset:2048 sc1
    buffer_load_dwordx4 v3, s[56:59], s82 offen offset:3072 sc1 lds
    s_add_u32 s82, s82, 16384
    s_bitset0_b32 s82, 17
    v_exp_f32 v109, v109
    v_exp_f32 v110, v110
    v_exp_f32 v111, v111
    v_exp_f32 v112, v112
    v_exp_f32 v113, v113
    v_exp_f32 v114, v114
    v_smfmac_f32_32x32x32_bf16 v[72:87], v[144:147], v[104:111], v2
    v_exp_f32 v115, v115
    v_exp_f32 v116, v116
    v_exp_f32 v117, v117
    v_exp_f32 v118, v118
    v_exp_f32 v119, v119
    v_exp_f32 v120, v120
    v_exp_f32 v121, v121
    v_smfmac_f32_32x32x32_bf16 v[72:87], v[148:151], v[112:119], v2
    v_mov_b32 v24, v152
    v_mov_b32 v25, v152
    v_mov_b64 v[26:27], v[24:25]
    v_mov_b64 v[28:29], v[24:25]
    v_mov_b64 v[30:31], v[24:25]
    v_mov_b64 v[32:33], v[24:25]
    v_mov_b64 v[34:35], v[24:25]
    v_mov_b64 v[36:37], v[24:25]
    v_mov_b64 v[38:39], v[24:25]
    v_exp_f32 v122, v122
    v_exp_f32 v123, v123
    s_waitcnt vmcnt(2)
    v_exp_f32 v124, v124
    v_mfma_f32_32x32x16_bf16 v[104:119], v[136:139], v[8:11], v[24:39]
    v_exp_f32 v125, v125
    v_exp_f32 v126, v126
    v_exp_f32 v127, v127
    v_exp_f32 v128, v128
    v_exp_f32 v129, v129
    v_exp_f32 v130, v130
    v_smfmac_f32_32x32x32_bf16 v[88:103], v[144:147], v[120:127], v2
    s_mov_b64 exec, s[80:81]
    ds_read_b128 v[144:147], v4 offset:0
    s_mov_b64 exec, -1
    v_exp_f32 v131, v131
    v_exp_f32 v132, v132
    v_exp_f32 v133, v133
    v_exp_f32 v134, v134
    v_exp_f32 v135, v135
    s_add_u32 s83, s83, 1
    s_cmp_lt_u32 s83, 8
    s_cbranch_scc1 L_fb_pass
    s_mov_b32 s70, 8
    v_mov_b32 v6, 7
    s_waitcnt vmcnt(0) lgkmcnt(0)
    ds_write_b32 v5, v6
    s_mov_b32 s88, 400000
L_28:
    ds_read_b32 v138, v163 offset:0
    s_waitcnt lgkmcnt(0)
    v_cmp_gt_u32 vcc, 7, v138
    s_cbranch_vccz L_29
    s_sub_u32 s88, s88, 1
    s_cmp_lg_u32 s88, 0
    s_cbranch_scc1 L_28
L_29:
    ds_write_b128 v160, v[40:43] offset:0
    ds_write_b128 v160, v[44:47] offset:1024
    ds_write_b32 v164, v48 offset:0
    ds_write_b128 v160, v[56:59] offset:2048
    ds_write_b128 v160, v[60:63] offset:3072
    ds_write_b32 v164, v64 offset:256
    v_mov_b32 v6, 8
    s_waitcnt lgkmcnt(0)
    ds_write_b32 v5, v6
    ds_read_b32 v7, v167
    ds_read_b32 v138, v163
    ds_read_b128 v[104:107], v161 offset:0
    ds_read_b128 v[108:111], v161 offset:1024
    ds_read_b128 v[112:115], v161 offset:2048
    ds_read_b128 v[116:119], v161 offset:3072
    ds_read2_b32 v[136:137], v165 offset0:0 offset1:64
    s_branch L_combine
L_asetup:
    s_load_dwordx2 s[40:41], s[0:1], 32
    s_load_dwordx2 s[52:53], s[0:1], 56
    s_load_dwordx2 s[56:57], s[0:1], 64
    s_mov_b32 s42, 0x180000
    s_mov_b32 s43, 0x00020000
    s_mov_b32 s54, 0x100
    s_mov_b32 s55, 0x00020000
    s_mov_b32 s58, 0xc00000
    s_mov_b32 s59, 0x00020000
    s_lshl_b32 s64, s61, 1
    s_and_b32 s68, s60, 1
    s_add_u32 s64, s64, s68
    s_lshl_b32 s64, s64, 3
    s_add_u32 s64, s64, s62
    s_lshl_b32 s64, s64, 1
    s_and_b32 s68, s61, 1
    s_add_u32 s64, s64, s68
    s_lshl_b32 s64, s64, 1
    s_bfe_u32 s68, s60, 0x10001
    s_add_u32 s64, s64, s68
    s_lshl_b32 s64, s64, 10
    s_add_u32 s64, s64, 4194304
    s_mov_b32 s80, 0xffff
    s_mov_b32 s81, 0xffff
    s_mov_b32 s87, 0
    s_lshr_b32 s69, s60, 3
    s_lshl_b32 s67, s69, 16
    s_xor_b32 s64, s64, s67
    s_lshl_b32 s67, s60, 2
    s_add_u32 s67, s67, 159744
    v_mov_b32 v5, s67
    v_mov_b32 v6, 0
    ds_write_b32 v5, v6
    ds_write_b32 v5, v6 offset:32
    v_mov_b32 v158, 159792
    s_and_b32 s70, s61, 24
    s_lshl_b32 s67, s69, 1
    s_and_b32 s68, s60, 1
    s_add_u32 s67, s67, s68
    s_add_u32 s76, s67, s70
    s_lshl_b32 s76, s76, 12
    s_lshl_b32 s67, s62, 5
    s_add_u32 s77, s67, s61
    s_add_u32 s67, s67, s70
    s_lshl_b32 s67, s67, 7
    s_add_u32 s67, s67, 8388608
    v_lshlrev_b32 v159, 7, v1
    v_add_u32 v159, s67, v159
    s_lshl_b32 s77, s77, 13
    s_add_u32 s77, s77, 10485760
    s_and_b32 s67, s60, 3
    s_lshl_b32 s70, s67, 6
    v_add_u32 v24, s70, v1
    v_lshlrev_b32 v26, 2, v24
    v_lshlrev_b32 v24, 4, v24
    v_xor_b32 v25, 1024, v24
    v_xor_b32 v27, 256, v26
    s_bfe_u32 s67, s64, 0x5000a
    s_lshl_b32 s67, s67, 17
    v_lshlrev_b32 v156, 4, v1
    v_add_u32 v3, s67, v156
    v_and_b32 v4, 15, v1
    v_lshlrev_b32 v4, 4, v4
    v_lshrrev_b32 v7, 5, v1
    v_lshl_add_u32 v4, v7, 8, v4
    s_sub_u32 s67, s60, 4
    s_mul_i32 s84, s67, 4608
    s_add_u32 s84, s84, 122880
    s_xor_b32 s68, s67, 4
    s_mul_i32 s78, s68, 4608
    s_add_u32 s78, s78, 122880
    s_xor_b32 s68, s67, 5
    s_mul_i32 s79, s68, 4608
    s_add_u32 s79, s79, 122880
    v_add_u32 v4, s84, v4
    v_add_u32 v160, s84, v156
    v_add_u32 v161, s78, v156
    v_add_u32 v162, s79, v156
    v_and_b32 v6, 1, v1
    v_and_b32 v7, 2, v1
    v_lshl_or_b32 v6, v7, 1, v6
    v_xor_b32 v6, s67, v6
    v_lshlrev_b32 v163, 2, v6
    v_add_u32 v163, 159760, v163
    v_and_b32 v157, 3, v1
    v_lshlrev_b32 v157, 2, v157
    v_add_u32 v157, 159744, v157
    v_mov_b32 v2, 0xdddd
    v_and_b32 v6, 27, v1
    v_cmp_eq_u32 vcc, 16, v6
    v_mov_b32 v6, 0x3f803f80
    s_nop 0
    v_cndmask_b32 v6, 0, v6, vcc
    v_mov_b32 v7, v6
    v_mov_b64 v[144:145], v[6:7]
    v_mov_b64 v[146:147], v[6:7]
    v_mov_b64 v[148:149], v[6:7]
    v_mov_b64 v[150:151], v[6:7]
    v_mov_b64 v[40:41], 0
    v_mov_b64 v[42:43], 0
    v_mov_b64 v[44:45], 0
    v_mov_b64 v[46:47], 0
    v_mov_b64 v[48:49], 0
    v_mov_b64 v[56:57], 0
    v_mov_b64 v[58:59], 0
    v_mov_b64 v[60:61], 0
    v_mov_b64 v[62:63], 0
    v_mov_b64 v[64:65], 0
    v_mov_b64 v[72:73], 0
    v_mov_b64 v[74:75], 0
    v_mov_b64 v[76:77], 0
    v_mov_b64 v[78:79], 0
    v_mov_b64 v[80:81], 0
    v_mov_b64 v[88:89], 0
    v_mov_b64 v[90:91], 0
    v_mov_b64 v[92:93], 0
    v_mov_b64 v[94:95], 0
    v_mov_b64 v[96:97], 0
    v_mov_b64 v[128:129], 0
    v_mov_b64 v[130:131], 0
    v_mov_b64 v[132:133], 0
    v_mov_b64 v[134:135], 0
    s_waitcnt lgkmcnt(0)
    s_setpc_b64 s[98:99]
L_spare:
    s_call_b64 s[98:99], L_asetup
    s_bfe_u32 s70, s2, 0x20001
    s_lshr_b32 s67, s2, 5
    s_lshl_b32 s67, s67, 2
    s_add_u32 s70, s70, s67
    s_and_b32 s67, s2, 0x19
    s_lshl_b32 s68, s60, 8
    s_or_b32 s67, s67, s68
    s_cmp_eq_u32 s67, 0x810
    s_cselect_b32 s70, s70, 64
    s_cmp_ge_u32 s70, 12
    s_cbranch_scc1 L_30
    v_lshlrev_b32 v20, 7, v1
    s_lshl_b32 s68, s70, 13
    s_add_u32 s68, s68, 8388608
    buffer_store_dwordx4 v[40:43], v20, s[56:59], s68 offen sc1
L_30:
    s_mov_b32 s85, 194
    s_setprio 3
    s_barrier
    s_barrier
    s_barrier
    s_barrier
    s_cmp_ge_u32 s70, 12
    s_cbranch_scc1 L_31
    s_lshl_b32 s67, s70, 2
    v_mov_b32 v21, 1
    s_waitcnt vmcnt(0)
    s_mov_b64 exec, 1
    buffer_store_dword v21, v156, s[52:55], s67 offen sc1
    s_mov_b64 exec, -1
L_31:
    s_barrier
    s_barrier
    s_barrier
    v_mov_b64 v[28:29], -1
    v_mov_b64 v[30:31], -1
    buffer_store_dwordx4 v[28:31], v24, s[56:59], s77 offen sc1
    s_barrier
    v_lshlrev_b32 v20, 2, v1
    s_cmp_lg_u32 s60, 8
    s_cbranch_scc1 L_32
    buffer_load_dword v21, v20, s[52:55], 0 offen sc1
L_32:
    s_barrier
    s_barrier
    s_barrier
    s_waitcnt vmcnt(0)
    s_cmp_lg_u32 s60, 8
    s_cbranch_scc1 L_33
    s_mov_b64 exec, 0xfff
    s_mov_b32 s88, 400000
    s_branch L_pchk_36
L_poll_34:
    buffer_load_dword v21, v20, s[52:55], 0 offen sc1
L_pchk_36:
    s_waitcnt vmcnt(0)
    v_cmp_ne_u32 vcc, 1, v21
    s_cbranch_vccz L_pdone_35
    s_sleep 4
    s_sub_u32 s88, s88, 1
    s_cmp_lg_u32 s88, 0
    s_cbranch_scc1 L_poll_34
L_pdone_35:
    s_mov_b64 exec, -1
    s_lshl_b32 s67, s62, 5
    s_add_u32 s67, s67, s61
    s_lshl_b32 s67, s67, 7
    s_add_u32 s67, s67, 8388608
    v_mov_b32 v21, 1
    s_mov_b64 exec, 1
    s_barrier
    buffer_store_dword v21, v20, s[56:59], s67 offen sc1
    s_mov_b64 exec, -1
    s_branch L_33b
L_33:
    s_barrier
L_33b:
    s_branch L_handover
L_gemm:
    s_setprio 2
    s_load_dwordx2 s[32:33], s[0:1], 16
    s_load_dwordx2 s[36:37], s[0:1], 24
    s_load_dwordx2 s[40:41], s[0:1], 32
    s_load_dwordx2 s[44:45], s[0:1], 40
    s_load_dwordx2 s[48:49], s[0:1], 48
    s_load_dwordx2 s[52:53], s[0:1], 56
    s_load_dwordx2 s[56:57], s[0:1], 64
    s_mov_b32 s34, 0x80000
    s_mov_b32 s35, 0x00020000
    s_mov_b32 s38, 0x200000
    s_mov_b32 s39, 0x00020000
    s_mov_b32 s42, 0x180000
    s_mov_b32 s43, 0x00020000
    s_mov_b32 s46, 0x80000
    s_mov_b32 s47, 0x00020000
    s_mov_b32 s50, 0x400000
    s_mov_b32 s51, 0x00020000
    s_mov_b32 s54, 0x100
    s_mov_b32 s55, 0x00020000
    s_mov_b32 s58, 0xc00000
    s_mov_b32 s59, 0x00020000
    s_lshl_b32 s64, s61, 1
    s_and_b32 s68, s60, 1
    s_add_u32 s64, s64, s68
    s_lshl_b32 s64, s64, 3
    s_add_u32 s64, s64, s62
    s_lshl_b32 s64, s64, 1
    s_and_b32 s68, s61, 1
    s_add_u32 s64, s64, s68
    s_lshl_b32 s64, s64, 1
    s_bfe_u32 s68, s60, 0x10001
    s_add_u32 s64, s64, s68
    s_lshl_b32 s64, s64, 10
    s_add_u32 s64, s64, 4194304
    s_and_b32 s67, s60, 3
    s_lshl_b32 s71, s67, 11
    s_lshl_b32 s68, s67, 4
    v_lshrrev_b32 v16, 3, v1
    v_add_u32 v17, s68, v16
    v_and_b32 v18, 7, v1
    v_lshrrev_b32 v19, 4, v1
    v_xor_b32 v20, v18, v19
    v_lshlrev_b32 v20, 4, v20
    v_and_b32 v19, 1, v19
    v_lshlrev_b32 v19, 2, v19
    v_xor_b32 v19, v18, v19
    v_lshlrev_b32 v19, 4, v19
    v_mul_u32_u24 v154, 3072, v17
    s_lshl_b32 s68, s62, 7
    v_add3_u32 v154, v154, v19, s68
    v_add_u32 v155, 23552, v154
    s_lshl_b32 s67, s61, 16
    v_and_b32 v18, 31, v17
    v_lshrrev_b32 v17, 5, v17
    v_lshl_add_u32 v17, v18, 1, v17
    v_lshl_add_u32 v152, v17, 10, v20
    v_add_u32 v152, s67, v152
    v_xor_b32 v153, 64, v152
    v_add_u32 v153, 15360, v153
    s_lshl_b32 s72, s62, 2
    s_add_u32 s72, s72, s61
    s_lshr_b32 s68, s62, 1
    s_add_u32 s72, s72, s68
    s_and_b32 s72, s72, 7
    s_lshl_b32 s72, s72, 7
    s_cmp_eq_u32 s61, 0
    s_cselect_b32 s75, 15, 0
    s_and_b32 s67, s2, 7
    s_lshl_b32 s65, s67, 2
    s_lshr_b32 s69, s2, 6
    s_or_b32 s65, s65, s69
    s_bfe_u32 s66, s2, 0x30003
    s_lshl_b32 s67, s66, 7
    v_lshl_add_u32 v166, v16, 10, v19
    v_add_u32 v166, s67, v166
    v_add_u32 v167, 7168, v166
    s_lshl_b32 s85, s65, 1
    s_add_u32 s85, s85, s66
    s_and_b32 s85, s85, 7
    s_lshl_b32 s84, s85, 16
    s_lshl_b32 s67, s71, 3
    s_add_u32 s84, s84, s67
    s_mov_b32 s89, 0x3eb8aa3b
    s_lshl_b32 s67, s60, 2
    s_add_u32 s67, s67, 159744
    v_mov_b32 v158, s67
    s_and_b32 s67, s60, 1
    s_lshr_b32 s68, s60, 1
    v_and_b32 v14, 31, v1
    v_lshrrev_b32 v15, 5, v1
    v_bfe_u32 v16, v1, 1, 3
    v_xor_b32 v16, v16, v15
    v_lshlrev_b32 v16, 4, v16
    v_lshl_add_u32 v2, v14, 7, v16
    s_lshl_b32 s69, s67, 12
    v_add_u32 v2, s69, v2
    v_xor_b32 v3, 32, v2
    v_xor_b32 v4, 64, v2
    v_xor_b32 v5, 96, v2
    v_bfe_u32 v16, v1, 2, 2
    v_lshl_add_u32 v17, v15, 3, v16
    v_and_b32 v18, 3, v1
    v_lshlrev_b32 v160, 2, v18
    v_add_u32 v160, 159744, v160
    v_lshlrev_b32 v18, 3, v18
    v_bfe_u32 v19, v1, 4, 1
    v_lshl_add_u32 v18, v19, 5, v18
    v_bfe_u32 v19, v1, 3, 1
    v_xor_b32 v19, s68, v19
    v_lshl_add_u32 v18, v19, 6, v18
    v_lshl_add_u32 v10, v17, 7, v18
    v_add_u32 v10, 24576, v10
    v_add_u32 v11, 0x10000, v10
    s_lshl_b32 s69, s67, 6
    v_add_u32 v164, s69, v1
    v_lshlrev_b32 v165, 2, v164
    v_lshlrev_b32 v164, 4, v164
    s_xor_b32 s87, s68, s61
    s_lshl_b32 s82, s62, 5
    s_add_u32 s82, s82, s61
    s_lshl_b32 s82, s82, 13
    s_add_u32 s82, s82, 10485760
    s_lshl_b32 s69, s62, 1
    s_add_u32 s69, s69, s68
    s_lshl_b32 s63, s69, 11
    s_lshl_b32 s69, s69, 18
    s_lshl_b32 s70, s61, 1
    s_add_u32 s70, s70, s67
    s_lshl_b32 s70, s70, 11
    s_add_u32 s69, s69, s70
    s_lshl_b32 s70, s70, 4
    s_add_u32 s63, s63, s70
    s_add_u32 s63, s63, 6291456
    s_lshl_b32 s86, s62, 5
    s_add_u32 s86, s86, s61
    s_lshl_b32 s101, s86, 2
    s_add_u32 s101, s101, s60
    s_lshl_b32 s101, s101, 10
    s_add_u32 s101, s101, 9437184
    s_lshl_b32 s86, s86, 5
    s_add_u32 s86, s86, s60
    s_lshl_b32 s86, s86, 2
    s_add_u32 s86, s86, 8388608
    v_and_b32 v16, 0x33, v1
    v_bfe_u32 v17, v1, 2, 1
    v_lshl_or_b32 v16, v17, 3, v16
    v_bfe_u32 v17, v1, 3, 1
    v_lshl_or_b32 v16, v17, 2, v16
    v_lshlrev_b32 v12, 4, v16
    v_add_u32 v12, s69, v12
    v_and_b32 v16, 15, v1
    v_lshlrev_b32 v16, 4, v16
    v_lshl_add_u32 v16, v15, 8, v16
    v_bfe_u32 v17, v1, 4, 1
    v_lshl_add_u32 v13, v17, 17, v16
    v_add_u32 v13, s69, v13
    v_lshlrev_b32 v0, 2, v1
    v_bfe_u32 v16, v1, 2, 2
    v_lshl_add_u32 v17, v15, 2, v16
    v_and_b32 v18, 1, v1
    v_lshlrev_b32 v18, 5, v18
    v_bfe_u32 v19, v1, 4, 1
    v_lshl_add_u32 v18, v19, 4, v18
    v_bfe_u32 v19, v1, 1, 1
    v_lshl_add_u32 v18, v19, 3, v18
    v_bfe_u32 v19, v1, 3, 1
    v_xor_b32 v19, s68, v19
    v_lshl_add_u32 v18, v19, 6, v18
    v_lshl_add_u32 v6, v17, 7, v18
    s_lshl_b32 s69, s68, 15
    v_add_u32 v6, s69, v6
    s_lshl_b32 s100, s65, 17
    s_lshl_b32 s69, s66, 7
    s_add_u32 s100, s100, s69
    s_lshl_b32 s69, s68, 6
    s_add_u32 s100, s100, s69
    v_lshrrev_b32 v16, 2, v1
    v_and_b32 v17, 3, v1
    v_lshl_add_u32 v7, v16, 1, s67
    v_lshlrev_b32 v7, 11, v7
    v_lshl_add_u32 v7, v17, 4, v7
    v_add_u32 v7, 1024, v7
    s_lshl_b32 s69, s67, 5
    v_add_u32 v9, s69, v16
    v_lshlrev_b32 v9, 11, v9
    v_lshl_add_u32 v9, v17, 4, v9
    s_lshl_b32 s69, s65, 16
    s_lshl_b32 s67, s67, 15
    s_add_u32 s69, s69, s67
    s_add_u32 s69, s69, 6291456
    s_lshl_b32 s68, s68, 2
    s_add_u32 s68, s68, s85
    s_add_u32 s67, s68, 0
    s_and_b32 s67, s67, 7
    s_lshl_b32 s67, s67, 12
    s_add_u32 s76, s69, s67
    s_add_u32 s67, s68, 1
    s_and_b32 s67, s67, 7
    s_lshl_b32 s67, s67, 12
    s_add_u32 s77, s69, s67
    s_add_u32 s67, s68, 2
    s_and_b32 s67, s67, 7
    s_lshl_b32 s67, s67, 12
    s_add_u32 s78, s69, s67
    s_add_u32 s67, s68, 3
    s_and_b32 s67, s67, 7
    s_lshl_b32 s67, s67, 12
    s_add_u32 s79, s69, s67
    s_lshl_b32 s67, s65, 7
    s_lshl_b32 s68, s60, 13
    s_add_u32 s67, s67, s68
    s_add_u32 s67, s67, 8421376
    v_and_b32 v8, 1, v1
    v_lshlrev_b32 v8, 12, v8
    v_add_u32 v8, s67, v8
    v_and_b32 v16, 2, v1
    v_lshlrev_b32 v16, 6, v16
    v_xor_b32 v8, v8, v16
    v_and_b32 v156, 7, v1
    v_lshl_add_u32 v156, v15, 3, v156
    v_lshlrev_b32 v156, 4, v156
    v_mov_b32 v16, 0
    ds_write_b32 v158, v16
    s_waitcnt lgkmcnt(0)
    s_barrier
    ds_read_b128 v[64:67], v2 offset:0
    ds_read_b64_tr_b16 v[68:69], v10 offset:40960
    ds_read_b64_tr_b16 v[70:71], v10 offset:41472
    ds_read_b64_tr_b16 v[72:73], v10 offset:49152
    ds_read_b64_tr_b16 v[74:75], v10 offset:49664
    ds_read_b128 v[76:79], v3 offset:0
    ds_read_b64_tr_b16 v[80:81], v10 offset:43008
    ds_read_b64_tr_b16 v[82:83], v10 offset:43520
    ds_read_b64_tr_b16 v[84:85], v10 offset:51200
    ds_read_b64_tr_b16 v[86:87], v10 offset:51712
    ds_read_b128 v[88:91], v4 offset:0
    ds_read_b64_tr_b16 v[92:93], v10 offset:45056
    ds_read_b64_tr_b16 v[94:95], v10 offset:45568
    ds_read_b64_tr_b16 v[96:97], v10 offset:53248
    ds_read_b64_tr_b16 v[98:99], v10 offset:53760
    s_waitcnt lgkmcnt(12)
    v_mfma_f32_32x32x16_bf16 v[16:31], v[68:71], v[64:67], 0
    ds_read_b128 v[100:103], v5 offset:0
    ds_read_b64_tr_b16 v[104:105], v10 offset:47104
    ds_read_b64_tr_b16 v[106:107], v10 offset:47616
    s_waitcnt lgkmcnt(13)
    v_mfma_f32_32x32x16_bf16 v[32:47], v[64:67], v[72:75], 0
    ds_read_b64_tr_b16 v[108:109], v10 offset:55296
    ds_read_b64_tr_b16 v[110:111], v10 offset:55808
    s_waitcnt lgkmcnt(12)
    v_mfma_f32_32x32x16_bf16 v[16:31], v[80:83], v[76:79], v[16:31]
    s_barrier
    ds_read_b128 v[64:67], v2 offset:8192
    ds_read_b64_tr_b16 v[68:69], v11 offset:32768
    ds_read_b64_tr_b16 v[70:71], v11 offset:33280
    s_waitcnt lgkmcnt(13)
    v_mfma_f32_32x32x16_bf16 v[32:47], v[76:79], v[84:87], v[32:47]
    ds_read_b64_tr_b16 v[72:73], v11 offset:40960
    ds_read_b64_tr_b16 v[74:75], v11 offset:41472
    s_waitcnt lgkmcnt(12)
    v_mfma_f32_32x32x16_bf16 v[16:31], v[92:95], v[88:91], v[16:31]
    ds_read_b128 v[76:79], v3 offset:8192
    ds_read_b64_tr_b16 v[80:81], v11 offset:34816
    ds_read_b64_tr_b16 v[82:83], v11 offset:35328
    s_waitcnt lgkmcnt(13)
    v_mfma_f32_32x32x16_bf16 v[32:47], v[88:91], v[96:99], v[32:47]
    ds_read_b64_tr_b16 v[84:85], v11 offset:43008
    ds_read_b64_tr_b16 v[86:87], v11 offset:43520
    s_waitcnt lgkmcnt(12)
    v_mfma_f32_32x32x16_bf16 v[16:31], v[104:107], v[100:103], v[16:31]
    ds_read_b128 v[88:91], v4 offset:8192
    ds_read_b64_tr_b16 v[92:93], v11 offset:36864
    ds_read_b64_tr_b16 v[94:95], v11 offset:37376
    s_waitcnt lgkmcnt(13)
    v_mfma_f32_32x32x16_bf16 v[32:47], v[100:103], v[108:111], v[32:47]
    ds_read_b64_tr_b16 v[96:97], v11 offset:45056
    ds_read_b64_tr_b16 v[98:99], v11 offset:45568
    s_waitcnt lgkmcnt(12)
    v_mfma_f32_32x32x16_bf16 v[16:31], v[68:71], v[64:67], v[16:31]
    ds_read_b128 v[100:103], v5 offset:8192
    ds_read_b64_tr_b16 v[104:105], v11 offset:38912
    ds_read_b64_tr_b16 v[106:107], v11 offset:39424
    s_waitcnt lgkmcnt(13)
    v_mfma_f32_32x32x16_bf16 v[32:47], v[64:67], v[72:75], v[32:47]
    ds_read_b64_tr_b16 v[108:109], v11 offset:47104
    ds_read_b64_tr_b16 v[110:111], v11 offset:47616
    s_waitcnt lgkmcnt(12)
    v_mfma_f32_32x32x16_bf16 v[16:31], v[80:83], v[76:79], v[16:31]
    s_barrier
    ds_read_b128 v[64:67], v2 offset:16384
    ds_read_b64_tr_b16 v[68:69], v11 offset:49152
    ds_read_b64_tr_b16 v[70:71], v11 offset:49664
    s_waitcnt lgkmcnt(13)
    v_mfma_f32_32x32x16_bf16 v[32:47], v[76:79], v[84:87], v[32:47]
    ds_read_b64_tr_b16 v[72:73], v11 offset:57344
    ds_read_b64_tr_b16 v[74:75], v11 offset:57856
    s_waitcnt lgkmcnt(12)
    v_mfma_f32_32x32x16_bf16 v[16:31], v[92:95], v[88:91], v[16:31]
    ds_read_b128 v[76:79], v3 offset:16384
    ds_read_b64_tr_b16 v[80:81], v11 offset:51200
    ds_read_b64_tr_b16 v[82:83], v11 offset:51712
    s_waitcnt lgkmcnt(13)
    v_mfma_f32_32x32x16_bf16 v[32:47], v[88:91], v[96:99], v[32:47]
    ds_read_b64_tr_b16 v[84:85], v11 offset:59392
    ds_read_b64_tr_b16 v[86:87], v11 offset:59904
    s_waitcnt lgkmcnt(12)
    v_mfma_f32_32x32x16_bf16 v[16:31], v[104:107], v[100:103], v[16:31]
    ds_read_b128 v[88:91], v4 offset:16384
    ds_read_b64_tr_b16 v[92:93], v11 offset:53248
    ds_read_b64_tr_b16 v[94:95], v11 offset:53760
    s_waitcnt lgkmcnt(13)
    v_mfma_f32_32x32x16_bf16 v[32:47], v[100:103], v[108:111], v[32:47]
    ds_read_b64_tr_b16 v[96:97], v11 offset:61440
    ds_read_b64_tr_b16 v[98:99], v11 offset:61952
    s_waitcnt lgkmcnt(12)
    v_mfma_f32_32x32x16_bf16 v[16:31], v[68:71], v[64:67], v[16:31]
    ds_read_b128 v[100:103], v5 offset:16384
    ds_read_b64_tr_b16 v[104:105], v11 offset:55296
    ds_read_b64_tr_b16 v[106:107], v11 offset:55808
    s_waitcnt lgkmcnt(13)
    v_mfma_f32_32x32x16_bf16 v[32:47], v[64:67], v[72:75], v[32:47]
    ds_read_b64_tr_b16 v[108:109], v11 offset:63488
    ds_read_b64_tr_b16 v[110:111], v11 offset:64000
    s_waitcnt lgkmcnt(12)
    v_mfma_f32_32x32x16_bf16 v[16:31], v[80:83], v[76:79], v[16:31]
    s_barrier
    ds_read_b128 v[64:67], v2 offset:24576
    ds_read_b64_tr_b16 v[68:69], v10 offset:57344
    ds_read_b64_tr_b16 v[70:71], v10 offset:57856
    s_waitcnt lgkmcnt(13)
    v_mfma_f32_32x32x16_bf16 v[32:47], v[76:79], v[84:87], v[32:47]
    ds_read_b64_tr_b16 v[72:73], v11 offset:0
    ds_read_b64_tr_b16 v[74:75], v11 offset:512
    s_waitcnt lgkmcnt(12)
    v_mfma_f32_32x32x16_bf16 v[16:31], v[92:95], v[88:91], v[16:31]
    ds_read_b128 v[76:79], v3 offset:24576
    ds_read_b64_tr_b16 v[80:81], v10 offset:59392
    ds_read_b64_tr_b16 v[82:83], v10 offset:59904
    s_waitcnt lgkmcnt(13)
    v_mfma_f32_32x32x16_bf16 v[32:47], v[88:91], v[96:99], v[32:47]
    ds_read_b64_tr_b16 v[84:85], v11 offset:2048
    ds_read_b64_tr_b16 v[86:87], v11 offset:2560
    s_waitcnt lgkmcnt(12)
    v_mfma_f32_32x32x16_bf16 v[16:31], v[104:107], v[100:103], v[16:31]
    ds_read_b128 v[88:91], v4 offset:24576
    ds_read_b64_tr_b16 v[92:93], v10 offset:61440
    ds_read_b64_tr_b16 v[94:95], v10 offset:61952
    s_waitcnt lgkmcnt(13)
    v_mfma_f32_32x32x16_bf16 v[32:47], v[100:103], v[108:111], v[32:47]
    ds_read_b64_tr_b16 v[96:97], v11 offset:4096
    ds_read_b64_tr_b16 v[98:99], v11 offset:4608
    s_waitcnt lgkmcnt(12)
    v_mfma_f32_32x32x16_bf16 v[16:31], v[68:71], v[64:67], v[16:31]
    ds_read_b128 v[100:103], v5 offset:24576
    ds_read_b64_tr_b16 v[104:105], v10 offset:63488
    ds_read_b64_tr_b16 v[106:107], v10 offset:64000
    s_waitcnt lgkmcnt(13)
    v_mfma_f32_32x32x16_bf16 v[32:47], v[64:67], v[72:75], v[32:47]
    ds_read_b64_tr_b16 v[108:109], v11 offset:6144
    ds_read_b64_tr_b16 v[110:111], v11 offset:6656
    s_waitcnt lgkmcnt(12)
    v_mfma_f32_32x32x16_bf16 v[16:31], v[80:83], v[76:79], v[16:31]
    s_barrier
    ds_read_b128 v[64:67], v2 offset:32768
    ds_read_b64_tr_b16 v[68:69], v11 offset:8192
    ds_read_b64_tr_b16 v[70:71], v11 offset:8704
    s_waitcnt lgkmcnt(13)
    v_mfma_f32_32x32x16_bf16 v[32:47], v[76:79], v[84:87], v[32:47]
    ds_read_b64_tr_b16 v[72:73], v11 offset:16384
    ds_read_b64_tr_b16 v[74:75], v11 offset:16896
    s_waitcnt lgkmcnt(12)
    v_mfma_f32_32x32x16_bf16 v[16:31], v[92:95], v[88:91], v[16:31]
    ds_read_b128 v[76:79], v3 offset:32768
    ds_read_b64_tr_b16 v[80:81], v11 offset:10240
    ds_read_b64_tr_b16 v[82:83], v11 offset:10752
    s_waitcnt lgkmcnt(13)
    v_mfma_f32_32x32x16_bf16 v[32:47], v[88:91], v[96:99], v[32:47]
    ds_read_b64_tr_b16 v[84:85], v11 offset:18432
    ds_read_b64_tr_b16 v[86:87], v11 offset:18944
    s_waitcnt lgkmcnt(12)
    v_mfma_f32_32x32x16_bf16 v[16:31], v[104:107], v[100:103], v[16:31]
    ds_read_b128 v[88:91], v4 offset:32768
    ds_read_b64_tr_b16 v[92:93], v11 offset:12288
    ds_read_b64_tr_b16 v[94:95], v11 offset:12800
    s_waitcnt lgkmcnt(13)
    v_mfma_f32_32x32x16_bf16 v[32:47], v[100:103], v[108:111], v[32:47]
    ds_read_b64_tr_b16 v[96:97], v11 offset:20480
    ds_read_b64_tr_b16 v[98:99], v11 offset:20992
    s_waitcnt lgkmcnt(12)
    v_mfma_f32_32x32x16_bf16 v[16:31], v[68:71], v[64:67], v[16:31]
    ds_read_b128 v[100:103], v5 offset:32768
    ds_read_b64_tr_b16 v[104:105], v11 offset:14336
    ds_read_b64_tr_b16 v[106:107], v11 offset:14848
    s_waitcnt lgkmcnt(13)
    v_mfma_f32_32x32x16_bf16 v[32:47], v[64:67], v[72:75], v[32:47]
    ds_read_b64_tr_b16 v[108:109], v11 offset:22528
    ds_read_b64_tr_b16 v[110:111], v11 offset:23040
    s_waitcnt lgkmcnt(12)
    v_mfma_f32_32x32x16_bf16 v[16:31], v[80:83], v[76:79], v[16:31]
    s_barrier
    ds_read_b128 v[64:67], v2 offset:40960
    ds_read_b64_tr_b16 v[68:69], v11 offset:24576
    ds_read_b64_tr_b16 v[70:71], v11 offset:25088
    s_waitcnt lgkmcnt(13)
    v_mfma_f32_32x32x16_bf16 v[32:47], v[76:79], v[84:87], v[32:47]
    ds_read_b64_tr_b16 v[72:73], v10 offset:40960
    ds_read_b64_tr_b16 v[74:75], v10 offset:41472
    s_waitcnt lgkmcnt(12)
    v_mfma_f32_32x32x16_bf16 v[16:31], v[92:95], v[88:91], v[16:31]
    ds_read_b128 v[76:79], v3 offset:40960
    ds_read_b64_tr_b16 v[80:81], v11 offset:26624
    ds_read_b64_tr_b16 v[82:83], v11 offset:27136
    s_waitcnt lgkmcnt(13)
    v_mfma_f32_32x32x16_bf16 v[32:47], v[88:91], v[96:99], v[32:47]
    ds_read_b64_tr_b16 v[84:85], v10 offset:43008
    ds_read_b64_tr_b16 v[86:87], v10 offset:43520
    s_waitcnt lgkmcnt(12)
    v_mfma_f32_32x32x16_bf16 v[16:31], v[104:107], v[100:103], v[16:31]
    ds_read_b128 v[88:91], v4 offset:40960
    ds_read_b64_tr_b16 v[92:93], v11 offset:28672
    ds_read_b64_tr_b16 v[94:95], v11 offset:29184
    s_waitcnt lgkmcnt(13)
    v_mfma_f32_32x32x16_bf16 v[32:47], v[100:103], v[108:111], v[32:47]
    ds_read_b64_tr_b16 v[96:97], v10 offset:45056
    ds_read_b64_tr_b16 v[98:99], v10 offset:45568
    s_waitcnt lgkmcnt(12)
    v_mfma_f32_32x32x16_bf16 v[16:31], v[68:71], v[64:67], v[16:31]
    ds_read_b128 v[100:103], v5 offset:40960
    ds_read_b64_tr_b16 v[104:105], v11 offset:30720
    ds_read_b64_tr_b16 v[106:107], v11 offset:31232
    s_waitcnt lgkmcnt(13)
    v_mfma_f32_32x32x16_bf16 v[32:47], v[64:67], v[72:75], v[32:47]
    ds_read_b64_tr_b16 v[108:109], v10 offset:47104
    ds_read_b64_tr_b16 v[110:111], v10 offset:47616
    s_waitcnt lgkmcnt(12)
    v_mfma_f32_32x32x16_bf16 v[16:31], v[80:83], v[76:79], v[16:31]
    s_barrier
    ds_read_b128 v[64:67], v2 offset:49152
    ds_read_b64_tr_b16 v[68:69], v10 offset:49152
    ds_read_b64_tr_b16 v[70:71], v10 offset:49664
    s_waitcnt lgkmcnt(13)
    v_mfma_f32_32x32x16_bf16 v[32:47], v[76:79], v[84:87], v[32:47]
    ds_read_b64_tr_b16 v[72:73], v11 offset:32768
    ds_read_b64_tr_b16 v[74:75], v11 offset:33280
    s_waitcnt lgkmcnt(12)
    v_mfma_f32_32x32x16_bf16 v[16:31], v[92:95], v[88:91], v[16:31]
    ds_read_b128 v[76:79], v3 offset:49152
    ds_read_b64_tr_b16 v[80:81], v10 offset:51200
    ds_read_b64_tr_b16 v[82:83], v10 offset:51712
    s_waitcnt lgkmcnt(13)
    v_mfma_f32_32x32x16_bf16 v[32:47], v[88:91], v[96:99], v[32:47]
    ds_read_b64_tr_b16 v[84:85], v11 offset:34816
    ds_read_b64_tr_b16 v[86:87], v11 offset:35328
    s_waitcnt lgkmcnt(12)
    v_mfma_f32_32x32x16_bf16 v[16:31], v[104:107], v[100:103], v[16:31]
    ds_read_b128 v[88:91], v4 offset:49152
    ds_read_b64_tr_b16 v[92:93], v10 offset:53248
    ds_read_b64_tr_b16 v[94:95], v10 offset:53760
    s_waitcnt lgkmcnt(13)
    v_mfma_f32_32x32x16_bf16 v[32:47], v[100:103], v[108:111], v[32:47]
    ds_read_b64_tr_b16 v[96:97], v11 offset:36864
    ds_read_b64_tr_b16 v[98:99], v11 offset:37376
    s_waitcnt lgkmcnt(12)
    v_mfma_f32_32x32x16_bf16 v[16:31], v[68:71], v[64:67], v[16:31]
    ds_read_b128 v[100:103], v5 offset:49152
    ds_read_b64_tr_b16 v[104:105], v10 offset:55296
    ds_read_b64_tr_b16 v[106:107], v10 offset:55808
    s_waitcnt lgkmcnt(13)
    v_mfma_f32_32x32x16_bf16 v[32:47], v[64:67], v[72:75], v[32:47]
    ds_read_b64_tr_b16 v[108:109], v11 offset:38912
    ds_read_b64_tr_b16 v[110:111], v11 offset:39424
    s_waitcnt lgkmcnt(12)
    v_mfma_f32_32x32x16_bf16 v[16:31], v[80:83], v[76:79], v[16:31]
    s_barrier
    ds_read_b128 v[64:67], v2 offset:57344
    ds_read_b64_tr_b16 v[68:69], v11 offset:40960
    ds_read_b64_tr_b16 v[70:71], v11 offset:41472
    s_waitcnt lgkmcnt(13)
    v_mfma_f32_32x32x16_bf16 v[32:47], v[76:79], v[84:87], v[32:47]
    ds_read_b64_tr_b16 v[72:73], v11 offset:49152
    ds_read_b64_tr_b16 v[74:75], v11 offset:49664
    s_waitcnt lgkmcnt(12)
    v_mfma_f32_32x32x16_bf16 v[16:31], v[92:95], v[88:91], v[16:31]
    ds_read_b128 v[76:79], v3 offset:57344
    ds_read_b64_tr_b16 v[80:81], v11 offset:43008
    ds_read_b64_tr_b16 v[82:83], v11 offset:43520
    s_waitcnt lgkmcnt(13)
    v_mfma_f32_32x32x16_bf16 v[32:47], v[88:91], v[96:99], v[32:47]
    ds_read_b64_tr_b16 v[84:85], v11 offset:51200
    ds_read_b64_tr_b16 v[86:87], v11 offset:51712
    s_waitcnt lgkmcnt(12)
    v_mfma_f32_32x32x16_bf16 v[16:31], v[104:107], v[100:103], v[16:31]
    ds_read_b128 v[88:91], v4 offset:57344
    ds_read_b64_tr_b16 v[92:93], v11 offset:45056
    ds_read_b64_tr_b16 v[94:95], v11 offset:45568
    s_waitcnt lgkmcnt(13)
    v_mfma_f32_32x32x16_bf16 v[32:47], v[100:103], v[108:111], v[32:47]
    ds_read_b64_tr_b16 v[96:97], v11 offset:53248
    ds_read_b64_tr_b16 v[98:99], v11 offset:53760
    s_waitcnt lgkmcnt(12)
    v_mfma_f32_32x32x16_bf16 v[16:31], v[68:71], v[64:67], v[16:31]
    ds_read_b128 v[100:103], v5 offset:57344
    ds_read_b64_tr_b16 v[104:105], v11 offset:47104
    ds_read_b64_tr_b16 v[106:107], v11 offset:47616
    s_waitcnt lgkmcnt(13)
    v_mfma_f32_32x32x16_bf16 v[32:47], v[64:67], v[72:75], v[32:47]
    ds_read_b64_tr_b16 v[108:109], v11 offset:55296
    ds_read_b64_tr_b16 v[110:111], v11 offset:55808
    s_waitcnt lgkmcnt(12)
    v_mfma_f32_32x32x16_bf16 v[16:31], v[80:83], v[76:79], v[16:31]
    s_waitcnt lgkmcnt(10)
    v_mfma_f32_32x32x16_bf16 v[32:47], v[76:79], v[84:87], v[32:47]
    s_waitcnt lgkmcnt(7)
    v_mfma_f32_32x32x16_bf16 v[16:31], v[92:95], v[88:91], v[16:31]
    s_waitcnt lgkmcnt(5)
    v_mfma_f32_32x32x16_bf16 v[32:47], v[88:91], v[96:99], v[32:47]
    s_waitcnt lgkmcnt(2)
    v_mfma_f32_32x32x16_bf16 v[16:31], v[104:107], v[100:103], v[16:31]
    s_waitcnt lgkmcnt(0)
    v_mfma_f32_32x32x16_bf16 v[32:47], v[100:103], v[108:111], v[32:47]
    s_nop 9
    s_mov_b32 s69, 0x20000
    v_cvt_pk_bf16_f32 v120, v16, v17
    v_cvt_pk_bf16_f32 v121, v18, v19
    v_cvt_pk_bf16_f32 v122, v20, v21
    v_cvt_pk_bf16_f32 v123, v22, v23
    v_cvt_pk_bf16_f32 v124, v24, v25
    v_cvt_pk_bf16_f32 v125, v26, v27
    v_cvt_pk_bf16_f32 v126, v28, v29
    v_cvt_pk_bf16_f32 v127, v30, v31
    buffer_store_dwordx4 v[120:123], v12, s[56:59], 0 offen sc1
    buffer_store_dwordx4 v[124:127], v12, s[56:59], s69 offen sc1
    v_cvt_pk_bf16_f32 v128, v32, v33
    v_cvt_pk_bf16_f32 v129, v34, v35
    v_cvt_pk_bf16_f32 v130, v36, v37
    v_cvt_pk_bf16_f32 v131, v38, v39
    v_cvt_pk_bf16_f32 v132, v40, v41
    v_cvt_pk_bf16_f32 v133, v42, v43
    v_cvt_pk_bf16_f32 v134, v44, v45
    v_cvt_pk_bf16_f32 v135, v46, v47
    buffer_store_dwordx4 v[128:131], v13, s[56:59], 0 offen offset:1024 sc1
    buffer_store_dwordx4 v[132:135], v13, s[56:59], 0 offen offset:1536 sc1
    v_mov_b32 v12, 1
    s_barrier
    ds_read_b128 v[64:67], v2 offset:0
    ds_read_b64_tr_b16 v[68:69], v11 offset:57344
    ds_read_b64_tr_b16 v[70:71], v11 offset:57856
    ds_read_b128 v[72:75], v3 offset:0
    ds_read_b64_tr_b16 v[76:77], v11 offset:59392
    ds_read_b64_tr_b16 v[78:79], v11 offset:59904
    ds_read_b128 v[80:83], v4 offset:0
    ds_read_b64_tr_b16 v[84:85], v11 offset:61440
    ds_read_b64_tr_b16 v[86:87], v11 offset:61952
    ds_read_b128 v[88:91], v5 offset:0
    ds_read_b64_tr_b16 v[92:93], v11 offset:63488
    ds_read_b64_tr_b16 v[94:95], v11 offset:64000
    ds_read_b128 v[96:99], v2 offset:8192
    ds_read_b64_tr_b16 v[100:101], v10 offset:57344
    ds_read_b64_tr_b16 v[102:103], v10 offset:57856
    s_waitcnt lgkmcnt(12)
    v_mfma_f32_32x32x16_bf16 v[48:63], v[68:71], v[64:67], 0
    ds_read_b128 v[104:107], v3 offset:8192
    ds_read_b64_tr_b16 v[108:109], v10 offset:59392
    ds_read_b64_tr_b16 v[110:111], v10 offset:59904
    s_waitcnt lgkmcnt(12)
    v_mfma_f32_32x32x16_bf16 v[48:63], v[76:79], v[72:75], v[48:63]
    ds_read_b128 v[112:115], v4 offset:8192
    ds_read_b64_tr_b16 v[116:117], v10 offset:61440
    ds_read_b64_tr_b16 v[118:119], v10 offset:61952
    s_waitcnt lgkmcnt(12)
    v_mfma_f32_32x32x16_bf16 v[48:63], v[84:87], v[80:83], v[48:63]
    ds_read_b128 v[64:67], v5 offset:8192
    ds_read_b64_tr_b16 v[68:69], v10 offset:63488
    ds_read_b64_tr_b16 v[70:71], v10 offset:64000
    s_waitcnt lgkmcnt(12)
    v_mfma_f32_32x32x16_bf16 v[48:63], v[92:95], v[88:91], v[48:63]
    s_barrier
    ds_read_b128 v[72:75], v2 offset:16384
    ds_read_b64_tr_b16 v[76:77], v11 offset:0
    ds_read_b64_tr_b16 v[78:79], v11 offset:512
    s_waitcnt lgkmcnt(12)
    v_mfma_f32_32x32x16_bf16 v[48:63], v[100:103], v[96:99], v[48:63]
    ds_read_b128 v[80:83], v3 offset:16384
    ds_read_b64_tr_b16 v[84:85], v11 offset:2048
    ds_read_b64_tr_b16 v[86:87], v11 offset:2560
    s_waitcnt lgkmcnt(12)
    v_mfma_f32_32x32x16_bf16 v[48:63], v[108:111], v[104:107], v[48:63]
    ds_read_b128 v[88:91], v4 offset:16384
    ds_read_b64_tr_b16 v[92:93], v11 offset:4096
    ds_read_b64_tr_b16 v[94:95], v11 offset:4608
    s_waitcnt lgkmcnt(12)
    v_mfma_f32_32x32x16_bf16 v[48:63], v[116:119], v[112:115], v[48:63]
    ds_read_b128 v[96:99], v5 offset:16384
    ds_read_b64_tr_b16 v[100:101], v11 offset:6144
    ds_read_b64_tr_b16 v[102:103], v11 offset:6656
    s_waitcnt lgkmcnt(12)
    v_mfma_f32_32x32x16_bf16 v[48:63], v[68:71], v[64:67], v[48:63]
    ds_read_b128 v[104:107], v2 offset:24576
    ds_read_b64_tr_b16 v[108:109], v11 offset:8192
    ds_read_b64_tr_b16 v[110:111], v11 offset:8704
    s_waitcnt lgkmcnt(12)
    v_mfma_f32_32x32x16_bf16 v[48:63], v[76:79], v[72:75], v[48:63]
    ds_read_b128 v[112:115], v3 offset:24576
    ds_read_b64_tr_b16 v[116:117], v11 offset:10240
    ds_read_b64_tr_b16 v[118:119], v11 offset:10752
    s_waitcnt lgkmcnt(12)
    v_mfma_f32_32x32x16_bf16 v[48:63], v[84:87], v[80:83], v[48:63]
    ds_read_b128 v[64:67], v4 offset:24576
    ds_read_b64_tr_b16 v[68:69], v11 offset:12288
    ds_read_b64_tr_b16 v[70:71], v11 offset:12800
    s_waitcnt lgkmcnt(12)
    v_mfma_f32_32x32x16_bf16 v[48:63], v[92:95], v[88:91], v[48:63]
    ds_read_b128 v[72:75], v5 offset:24576
    ds_read_b64_tr_b16 v[76:77], v11 offset:14336
    ds_read_b64_tr_b16 v[78:79], v11 offset:14848
    s_waitcnt lgkmcnt(12)
    v_mfma_f32_32x32x16_bf16 v[48:63], v[100:103], v[96:99], v[48:63]
    s_barrier
    ds_read_b128 v[80:83], v2 offset:32768
    ds_read_b64_tr_b16 v[84:85], v11 offset:16384
    ds_read_b64_tr_b16 v[86:87], v11 offset:16896
    s_waitcnt lgkmcnt(12)
    v_mfma_f32_32x32x16_bf16 v[48:63], v[108:111], v[104:107], v[48:63]
    ds_read_b128 v[88:91], v3 offset:32768
    ds_read_b64_tr_b16 v[92:93], v11 offset:18432
    ds_read_b64_tr_b16 v[94:95], v11 offset:18944
    s_waitcnt lgkmcnt(12)
    v_mfma_f32_32x32x16_bf16 v[48:63], v[116:119], v[112:115], v[48:63]
    ds_read_b128 v[96:99], v4 offset:32768
    ds_read_b64_tr_b16 v[100:101], v11 offset:20480
    ds_read_b64_tr_b16 v[102:103], v11 offset:20992
    s_waitcnt lgkmcnt(12)
    v_mfma_f32_32x32x16_bf16 v[48:63], v[68:71], v[64:67], v[48:63]
    ds_read_b128 v[104:107], v5 offset:32768
    ds_read_b64_tr_b16 v[108:109], v11 offset:22528
    ds_read_b64_tr_b16 v[110:111], v11 offset:23040
    s_waitcnt lgkmcnt(12)
    v_mfma_f32_32x32x16_bf16 v[48:63], v[76:79], v[72:75], v[48:63]
    ds_read_b128 v[112:115], v2 offset:40960
    ds_read_b64_tr_b16 v[116:117], v10 offset:40960
    ds_read_b64_tr_b16 v[118:119], v10 offset:41472
    s_waitcnt lgkmcnt(12)
    v_mfma_f32_32x32x16_bf16 v[48:63], v[84:87], v[80:83], v[48:63]
    ds_read_b128 v[64:67], v3 offset:40960
    ds_read_b64_tr_b16 v[68:69], v10 offset:43008
    ds_read_b64_tr_b16 v[70:71], v10 offset:43520
    s_waitcnt lgkmcnt(12)
    v_mfma_f32_32x32x16_bf16 v[48:63], v[92:95], v[88:91], v[48:63]
    ds_read_b128 v[72:75], v4 offset:40960
    ds_read_b64_tr_b16 v[76:77], v10 offset:45056
    ds_read_b64_tr_b16 v[78:79], v10 offset:45568
    s_waitcnt lgkmcnt(12)
    v_mfma_f32_32x32x16_bf16 v[48:63], v[100:103], v[96:99], v[48:63]
    ds_read_b128 v[80:83], v5 offset:40960
    ds_read_b64_tr_b16 v[84:85], v10 offset:47104
    ds_read_b64_tr_b16 v[86:87], v10 offset:47616
    s_waitcnt lgkmcnt(12)
    v_mfma_f32_32x32x16_bf16 v[48:63], v[108:111], v[104:107], v[48:63]
    s_waitcnt vmcnt(0)
    s_barrier
    ds_read_b128 v[88:91], v2 offset:49152
    ds_read_b64_tr_b16 v[92:93], v11 offset:24576
    ds_read_b64_tr_b16 v[94:95], v11 offset:25088
    s_waitcnt lgkmcnt(12)
    v_mfma_f32_32x32x16_bf16 v[48:63], v[116:119], v[112:115], v[48:63]
    ds_read_b128 v[96:99], v3 offset:49152
    ds_read_b64_tr_b16 v[100:101], v11 offset:26624
    ds_read_b64_tr_b16 v[102:103], v11 offset:27136
    s_waitcnt lgkmcnt(12)
    v_mfma_f32_32x32x16_bf16 v[48:63], v[68:71], v[64:67], v[48:63]
    ds_read_b128 v[104:107], v4 offset:49152
    ds_read_b64_tr_b16 v[108:109], v11 offset:28672
    ds_read_b64_tr_b16 v[110:111], v11 offset:29184
    s_waitcnt lgkmcnt(12)
    v_mfma_f32_32x32x16_bf16 v[48:63], v[76:79], v[72:75], v[48:63]
    ds_read_b128 v[112:115], v5 offset:49152
    ds_read_b64_tr_b16 v[116:117], v11 offset:30720
    ds_read_b64_tr_b16 v[118:119], v11 offset:31232
    s_waitcnt lgkmcnt(12)
    v_mfma_f32_32x32x16_bf16 v[48:63], v[84:87], v[80:83], v[48:63]
    ds_read_b128 v[64:67], v2 offset:57344
    ds_read_b64_tr_b16 v[68:69], v10 offset:49152
    ds_read_b64_tr_b16 v[70:71], v10 offset:49664
    s_waitcnt lgkmcnt(12)
    v_mfma_f32_32x32x16_bf16 v[48:63], v[92:95], v[88:91], v[48:63]
    ds_read_b128 v[72:75], v3 offset:57344
    ds_read_b64_tr_b16 v[76:77], v10 offset:51200
    ds_read_b64_tr_b16 v[78:79], v10 offset:51712
    s_waitcnt lgkmcnt(12)
    v_mfma_f32_32x32x16_bf16 v[48:63], v[100:103], v[96:99], v[48:63]
    ds_read_b128 v[80:83], v4 offset:57344
    ds_read_b64_tr_b16 v[84:85], v10 offset:53248
    ds_read_b64_tr_b16 v[86:87], v10 offset:53760
    s_waitcnt lgkmcnt(12)
    v_mfma_f32_32x32x16_bf16 v[48:63], v[108:111], v[104:107], v[48:63]
    ds_read_b128 v[88:91], v5 offset:57344
    ds_read_b64_tr_b16 v[92:93], v10 offset:55296
    ds_read_b64_tr_b16 v[94:95], v10 offset:55808
    s_waitcnt lgkmcnt(12)
    v_mfma_f32_32x32x16_bf16 v[48:63], v[116:119], v[112:115], v[48:63]
    s_waitcnt lgkmcnt(9)
    v_mfma_f32_32x32x16_bf16 v[48:63], v[68:71], v[64:67], v[48:63]
    s_waitcnt lgkmcnt(6)
    v_mfma_f32_32x32x16_bf16 v[48:63], v[76:79], v[72:75], v[48:63]
    s_waitcnt lgkmcnt(3)
    v_mfma_f32_32x32x16_bf16 v[48:63], v[84:87], v[80:83], v[48:63]
    s_waitcnt lgkmcnt(0)
    v_mfma_f32_32x32x16_bf16 v[48:63], v[92:95], v[88:91], v[48:63]
    s_nop 11
    v_mul_f32 v48, s89, v48
    v_mul_f32 v49, s89, v49
    v_mul_f32 v50, s89, v50
    v_mul_f32 v51, s89, v51
    v_mul_f32 v52, s89, v52
    v_mul_f32 v53, s89, v53
    v_mul_f32 v54, s89, v54
    v_mul_f32 v55, s89, v55
    v_mul_f32 v56, s89, v56
    v_mul_f32 v57, s89, v57
    v_mul_f32 v58, s89, v58
    v_mul_f32 v59, s89, v59
    v_mul_f32 v60, s89, v60
    v_mul_f32 v61, s89, v61
    v_mul_f32 v62, s89, v62
    v_mul_f32 v63, s89, v63
    v_cvt_pk_bf16_f32 v136, v48, v49
    v_cvt_pk_bf16_f32 v137, v50, v51
    v_cvt_pk_bf16_f32 v138, v52, v53
    v_cvt_pk_bf16_f32 v139, v54, v55
    v_cvt_pk_bf16_f32 v140, v56, v57
    v_cvt_pk_bf16_f32 v141, v58, v59
    v_cvt_pk_bf16_f32 v142, v60, v61
    v_cvt_pk_bf16_f32 v143, v62, v63
    s_bitcmp0_b32 s87, 0
    s_cbranch_scc1 L_qkeep
    v_min_u32 v136, -2, v136
    v_min_u32 v137, -2, v137
    v_min_u32 v138, -2, v138
    v_min_u32 v139, -2, v139
    v_min_u32 v140, -2, v140
    v_min_u32 v141, -2, v141
    v_min_u32 v142, -2, v142
    v_min_u32 v143, -2, v143
    buffer_store_dwordx4 v[136:139], v164, s[56:59], s82 offen sc1
    buffer_store_dwordx4 v[140:143], v164, s[56:59], s82 offen offset:2048 sc1
    s_branch L_qsent
L_qkeep:
    v_mfma_f32_32x32x16_bf16 v[16:31], v[120:123], v[136:139], 0
    v_mfma_f32_32x32x16_bf16 v[32:47], v[124:127], v[140:143], 0
    ds_write_b128 v164, v[136:139] offset:0
    ds_write_b128 v164, v[140:143] offset:2048
    s_nop 8
    v_max3_f32 v162, v16, v17, v18
    v_max3_f32 v162, v162, v19, v20
    v_max3_f32 v162, v162, v21, v22
    v_max3_f32 v162, v162, v23, v24
    v_max3_f32 v162, v162, v25, v26
    v_max3_f32 v162, v162, v27, v28
    v_max3_f32 v162, v162, v29, v30
    v_max_f32 v162, v162, v31
    v_mov_b32 v16, v162
    v_max3_f32 v163, v32, v33, v34
    v_max3_f32 v163, v163, v35, v36
    v_max3_f32 v163, v163, v37, v38
    v_max3_f32 v163, v163, v39, v40
    v_max3_f32 v163, v163, v41, v42
    v_max3_f32 v163, v163, v43, v44
    v_max3_f32 v163, v163, v45, v46
    v_max_f32 v163, v163, v47
    v_mov_b32 v32, v163
    s_nop 1
    v_permlane32_swap_b32 v162, v16
    v_permlane32_swap_b32 v163, v32
    s_nop 1
    v_max_f32 v162, v162, v16
    v_sub_f32 v162, 0, v162
    v_max_f32 v163, v163, v32
    v_sub_f32 v163, 0, v163
    ds_write_b32 v165, v162 offset:4096
    ds_write_b32 v165, v163 offset:4608
L_qsent:
    s_waitcnt lgkmcnt(0)
    s_barrier
    s_setprio 0
    v_mov_b32 v159, 2
    v_mov_b32 v162, 0x1fe
    v_mov_b32 v163, 0
    v_lshlrev_b64 v[162:163], v14, v[162:163]
    v_lshlrev_b32 v164, 2, v15
    v_lshrrev_b64 v[162:163], v164, v[162:163]
    v_alignbit_b32 v163, v163, v162, 8
    v_not_b32 v163, v163
    v_not_b32 v162, v162
    v_or_b32 v162, s75, v162
    v_mov_b32 v164, 0x07070303
    v_lshlrev_b32 v13, 4, v1
    v_lshlrev_b32 v157, 3, v1
    v_mov_b64 v[112:113], -1
    v_mov_b64 v[114:115], -1
    s_add_u32 s67, s86, 65408
    v_mov_b32 v150, s67
    s_lshl_b32 s67, s62, 2
    s_add_u32 s67, s67, s60
    s_lshl_b32 s67, s67, 10
    s_add_u32 s67, s67, 8388608
    v_lshlrev_b32 v165, 7, v1
    v_add_u32 v165, s67, v165
    v_bfe_i32 v124, v163, 0, 1
    v_lshlrev_b32 v124, 23, v124
    v_bfe_i32 v125, v163, 1, 1
    v_lshlrev_b32 v125, 23, v125
    v_bfe_i32 v126, v163, 2, 1
    v_lshlrev_b32 v126, 23, v126
    v_bfe_i32 v127, v163, 3, 1
    v_lshlrev_b32 v127, 23, v127
    v_bfe_i32 v128, v163, 8, 1
    v_lshlrev_b32 v128, 23, v128
    v_bfe_i32 v129, v163, 9, 1
    v_lshlrev_b32 v129, 23, v129
    v_bfe_i32 v130, v163, 10, 1
    v_lshlrev_b32 v130, 23, v130
    v_bfe_i32 v131, v163, 11, 1
    v_lshlrev_b32 v131, 23, v131
    v_bfe_i32 v132, v163, 16, 1
    v_lshlrev_b32 v132, 23, v132
    v_bfe_i32 v133, v163, 17, 1
    v_lshlrev_b32 v133, 23, v133
    v_bfe_i32 v134, v163, 18, 1
    v_lshlrev_b32 v134, 23, v134
    v_bfe_i32 v135, v163, 19, 1
    v_lshlrev_b32 v135, 23, v135
    v_bfe_i32 v136, v163, 24, 1
    v_lshlrev_b32 v136, 23, v136
    v_bfe_i32 v137, v163, 25, 1
    v_lshlrev_b32 v137, 23, v137
    v_bfe_i32 v138, v163, 26, 1
    v_lshlrev_b32 v138, 23, v138
    v_bfe_i32 v139, v163, 27, 1
    v_lshlrev_b32 v139, 23, v139
    v_bfe_i32 v120, v162, 0, 1
    v_lshlrev_b32 v120, 23, v120
    v_bfe_i32 v121, v162, 1, 1
    v_lshlrev_b32 v121, 23, v121
    v_bfe_i32 v122, v162, 2, 1
    v_lshlrev_b32 v122, 23, v122
    v_bfe_i32 v123, v162, 3, 1
    v_lshlrev_b32 v123, 23, v123
    v_perm_b32 v140, v125, v124, v164
    v_perm_b32 v141, v127, v126, v164
    v_perm_b32 v142, v129, v128, v164
    v_perm_b32 v143, v131, v130, v164
    v_perm_b32 v144, v133, v132, v164
    v_perm_b32 v145, v135, v134, v164
    v_perm_b32 v146, v137, v136, v164
    v_perm_b32 v147, v139, v138, v164
    v_perm_b32 v148, v121, v120, v164
    v_perm_b32 v149, v123, v122, v164
    s_setprio 3
    s_mov_b32 s88, 400000
L_37:
    ds_read_b32 v161, v160 offset:32
    s_waitcnt lgkmcnt(0)
    v_cmp_gt_u32 vcc, 1, v161
    s_cbranch_vccz L_38
    s_sleep 1
    s_sub_u32 s88, s88, 1
    s_cmp_lg_u32 s88, 0
    s_cbranch_scc1 L_37
L_38:
    s_mov_b32 s88, 400000
L_39:
    ds_read_b32 v161, v160 offset:16
    s_waitcnt lgkmcnt(0)
    v_cmp_gt_u32 vcc, 1, v161
    s_cbranch_vccz L_40
    s_sleep 1
    s_sub_u32 s88, s88, 1
    s_cmp_lg_u32 s88, 0
    s_cbranch_scc1 L_39
L_40:
    s_mov_b64 exec, 0xff
    buffer_load_dword v164, v165, s[56:59], 0 offen sc1
    s_mov_b64 exec, -1
    s_add_u32 m0, s71, 0
    s_mov_b32 s73, s72
    s_mul_i32 s74, s73, 1536
    buffer_load_dwordx4 v152, s[36:39], s73 offen lds
    buffer_load_dwordx4 v153, s[36:39], s73 offen offset:1024 lds
    s_waitcnt vmcnt(2)
    s_mov_b64 exec, 0xff
    v_cmp_ne_u32 vcc, 1, v164
    s_mov_b64 exec, -1
    s_cbranch_vccz L_41
    s_mov_b64 exec, 0xff
    s_mov_b32 s88, 400000
L_poll_42:
    buffer_load_dword v164, v165, s[56:59], 0 offen sc1
L_pchk_44:
    s_waitcnt vmcnt(0)
    v_cmp_ne_u32 vcc, 1, v164
    s_cbranch_vccz L_pdone_43
    s_sleep 2
    s_sub_u32 s88, s88, 1
    s_cmp_lg_u32 s88, 0
    s_cbranch_scc1 L_poll_42
L_pdone_43:
    s_mov_b64 exec, -1
L_41:
    ds_write_b32 v158, v159
    s_waitcnt lgkmcnt(0)
    v_mov_b32 v159, 3
    s_waitcnt vmcnt(0)
    s_add_u32 m0, s71, 73728
    s_add_u32 s67, s74, 0
    buffer_load_dwordx4 v154, s[40:43], s67 offen lds
    buffer_load_dwordx4 v155, s[40:43], s67 offen offset:1024 lds
    s_waitcnt vmcnt(0)
    s_add_u32 m0, s71, 32768
    s_add_u32 s67, s74, 1024
    buffer_load_dwordx4 v154, s[40:43], s67 offen lds
    buffer_load_dwordx4 v155, s[40:43], s67 offen offset:1024 lds
    s_waitcnt vmcnt(0)
    s_add_u32 m0, s71, 49152
    s_add_u32 s67, s74, 2048
    buffer_load_dwordx4 v154, s[40:43], s67 offen lds
    buffer_load_dwordx4 v155, s[40:43], s67 offen offset:1024 lds
    buffer_store_dwordx4 v[112:115], v13, s[56:59], s101 offen sc1
    s_waitcnt vmcnt(0)
    s_add_u32 m0, s71, 8192
    s_add_u32 s73, s72, 128
    s_and_b32 s73, s73, 1023
    s_mul_i32 s74, s73, 1536
    buffer_load_dwordx4 v152, s[36:39], s73 offen lds
    buffer_load_dwordx4 v153, s[36:39], s73 offen offset:1024 lds
    s_add_u32 s67, s86, 65536
    s_mov_b64 exec, 1
    buffer_store_dword v12, v0, s[56:59], s67 offen sc1
    s_mov_b64 exec, -1
    s_waitcnt vmcnt(0)
    s_add_u32 m0, s71, 65536
    s_add_u32 s67, s74, 0
    buffer_load_dwordx4 v154, s[40:43], s67 offen lds
    buffer_load_dwordx4 v155, s[40:43], s67 offen offset:1024 lds
    s_add_u32 m0, s71, 24576
    s_add_u32 s67, s74, 1024
    buffer_load_dwordx4 v154, s[40:43], s67 offen lds
    buffer_load_dwordx4 v155, s[40:43], s67 offen offset:1024 lds
    s_add_u32 m0, s71, 40960
    s_add_u32 s67, s74, 2048
    buffer_load_dwordx4 v154, s[40:43], s67 offen lds
    buffer_load_dwordx4 v155, s[40:43], s67 offen offset:1024 lds
    s_setprio 0
    s_waitcnt vmcnt(8)
    ds_write_b32 v158, v159
    s_setprio 3
    s_mov_b32 s88, 400000
L_45:
    ds_read_b32 v161, v160 offset:0
    s_waitcnt lgkmcnt(0)
    v_cmp_gt_u32 vcc, 3, v161
    s_cbranch_vccz L_46
    s_sub_u32 s88, s88, 1
    s_cmp_lg_u32 s88, 0
    s_cbranch_scc1 L_45
L_46:
    v_mov_b32 v159, 4
    s_setprio 0
    ds_read_b128 v[64:67], v2 offset:0
    ds_read_b64_tr_b16 v[72:73], v10 offset:8192
    ds_read_b64_tr_b16 v[74:75], v10 offset:8704
    ds_read_b64_tr_b16 v[76:77], v10 offset:24576
    ds_read_b64_tr_b16 v[78:79], v10 offset:25088
    s_waitcnt lgkmcnt(2)
    v_mfma_f32_32x32x16_bf16 v[32:47], v[72:75], v[64:67], 0
    ds_read_b64_tr_b16 v[68:69], v10 offset:49152
    ds_read_b64_tr_b16 v[70:71], v10 offset:49664
    s_waitcnt lgkmcnt(2)
    v_mfma_f32_32x32x16_bf16 v[48:63], v[64:67], v[76:79], 0
    ds_read_b128 v[80:83], v3 offset:0
    ds_read_b64_tr_b16 v[88:89], v10 offset:10240
    ds_read_b64_tr_b16 v[90:91], v10 offset:10752
    s_waitcnt lgkmcnt(3)
    v_mfma_f32_32x32x16_bf16 v[16:31], v[68:71], v[64:67], 0
    s_add_u32 s73, s72, 256
    s_and_b32 s73, s73, 1023
    s_mul_i32 s74, s73, 1536
    s_add_u32 m0, s71, 57344
    s_add_u32 s67, s74, 0
    buffer_load_dwordx4 v154, s[40:43], s67 offen lds
    buffer_load_dwordx4 v155, s[40:43], s67 offen offset:1024 lds
    ds_read_b64_tr_b16 v[92:93], v10 offset:26624
    ds_read_b64_tr_b16 v[94:95], v10 offset:27136
    s_waitcnt lgkmcnt(2)
    v_mfma_f32_32x32x16_bf16 v[32:47], v[88:91], v[80:83], v[32:47]
    ds_read_b64_tr_b16 v[84:85], v10 offset:51200
    ds_read_b64_tr_b16 v[86:87], v10 offset:51712
    s_waitcnt lgkmcnt(2)
    v_mfma_f32_32x32x16_bf16 v[48:63], v[80:83], v[92:95], v[48:63]
    ds_read_b128 v[96:99], v4 offset:0
    ds_read_b64_tr_b16 v[104:105], v10 offset:12288
    ds_read_b64_tr_b16 v[106:107], v10 offset:12800
    s_waitcnt lgkmcnt(3)
    v_mfma_f32_32x32x16_bf16 v[16:31], v[84:87], v[80:83], v[16:31]
    s_add_u32 m0, s71, 81920
    s_add_u32 s67, s74, 1024
    buffer_load_dwordx4 v154, s[40:43], s67 offen lds
    buffer_load_dwordx4 v155, s[40:43], s67 offen offset:1024 lds
    ds_read_b64_tr_b16 v[108:109], v10 offset:28672
    ds_read_b64_tr_b16 v[110:111], v10 offset:29184
    s_waitcnt lgkmcnt(2)
    v_mfma_f32_32x32x16_bf16 v[32:47], v[104:107], v[96:99], v[32:47]
    ds_read_b64_tr_b16 v[100:101], v10 offset:53248
    ds_read_b64_tr_b16 v[102:103], v10 offset:53760
    s_waitcnt lgkmcnt(2)
    v_mfma_f32_32x32x16_bf16 v[48:63], v[96:99], v[108:111], v[48:63]
    s_waitcnt vmcnt(4)
    ds_write_b32 v158, v159
    ds_read_b128 v[64:67], v5 offset:0
    ds_read_b64_tr_b16 v[72:73], v10 offset:14336
    ds_read_b64_tr_b16 v[74:75], v10 offset:14848
    s_waitcnt lgkmcnt(4)
    v_mfma_f32_32x32x16_bf16 v[16:31], v[100:103], v[96:99], v[16:31]
    s_add_u32 m0, s71, 90112
    s_add_u32 s67, s74, 2048
    buffer_load_dwordx4 v154, s[40:43], s67 offen lds
    buffer_load_dwordx4 v155, s[40:43], s67 offen offset:1024 lds
    ds_read_b64_tr_b16 v[76:77], v10 offset:30720
    ds_read_b64_tr_b16 v[78:79], v10 offset:31232
    s_waitcnt lgkmcnt(2)
    v_mfma_f32_32x32x16_bf16 v[32:47], v[72:75], v[64:67], v[32:47]
    ds_read_b32 v161, v160
    ds_read_b64_tr_b16 v[68:69], v10 offset:55296
    ds_read_b64_tr_b16 v[70:71], v10 offset:55808
    s_waitcnt lgkmcnt(3)
    v_mfma_f32_32x32x16_bf16 v[48:63], v[64:67], v[76:79], v[48:63]
    s_waitcnt lgkmcnt(2)
    s_setprio 3
    v_cmp_gt_u32 vcc, 4, v161
    s_cbranch_vccz L_48
    s_mov_b32 s88, 400000
L_47:
    ds_read_b32 v161, v160 offset:0
    s_waitcnt lgkmcnt(0)
    v_cmp_gt_u32 vcc, 4, v161
    s_cbranch_vccz L_48
    s_sub_u32 s88, s88, 1
    s_cmp_lg_u32 s88, 0
    s_cbranch_scc1 L_47
L_48:
    v_mov_b32 v159, 5
    s_setprio 0
    ds_read_b128 v[80:83], v2 offset:8192
    ds_read_b64_tr_b16 v[88:89], v10 offset:0
    ds_read_b64_tr_b16 v[90:91], v10 offset:512
    s_waitcnt lgkmcnt(3)
    v_mfma_f32_32x32x16_bf16 v[16:31], v[68:71], v[64:67], v[16:31]
    s_add_u32 m0, s71, 16384
    s_nop 0
    buffer_load_dwordx4 v152, s[36:39], s73 offen lds
    buffer_load_dwordx4 v153, s[36:39], s73 offen offset:1024 lds
    ds_read_b64_tr_b16 v[92:93], v10 offset:16384
    ds_read_b64_tr_b16 v[94:95], v10 offset:16896
    s_waitcnt lgkmcnt(2)
    v_mfma_f32_32x32x16_bf16 v[32:47], v[88:91], v[80:83], v[32:47]
    ds_read_b64_tr_b16 v[84:85], v10 offset:40960
    ds_read_b64_tr_b16 v[86:87], v10 offset:41472
    s_waitcnt lgkmcnt(2)
    v_mfma_f32_32x32x16_bf16 v[48:63], v[80:83], v[92:95], v[48:63]
    ds_read_b128 v[96:99], v3 offset:8192
    ds_read_b64_tr_b16 v[104:105], v10 offset:2048
    ds_read_b64_tr_b16 v[106:107], v10 offset:2560
    s_waitcnt lgkmcnt(3)
    v_mfma_f32_32x32x16_bf16 v[16:31], v[84:87], v[80:83], v[16:31]
    s_add_u32 s73, s72, 384
    s_and_b32 s73, s73, 1023
    s_mul_i32 s74, s73, 1536
    s_add_u32 m0, s71, 98304
    s_add_u32 s67, s74, 0
    buffer_load_dwordx4 v154, s[40:43], s67 offen lds
    buffer_load_dwordx4 v155, s[40:43], s67 offen offset:1024 lds
    ds_read_b64_tr_b16 v[108:109], v10 offset:18432
    ds_read_b64_tr_b16 v[110:111], v10 offset:18944
    s_waitcnt lgkmcnt(2)
    v_mfma_f32_32x32x16_bf16 v[32:47], v[104:107], v[96:99], v[32:47]
    ds_read_b64_tr_b16 v[100:101], v10 offset:43008
    ds_read_b64_tr_b16 v[102:103], v10 offset:43520
    s_waitcnt lgkmcnt(2)
    v_mfma_f32_32x32x16_bf16 v[48:63], v[96:99], v[108:111], v[48:63]
    ds_read_b128 v[64:67], v4 offset:8192
    ds_read_b64_tr_b16 v[72:73], v10 offset:4096
    ds_read_b64_tr_b16 v[74:75], v10 offset:4608
    s_waitcnt lgkmcnt(3)
    v_mfma_f32_32x32x16_bf16 v[16:31], v[100:103], v[96:99], v[16:31]
    s_add_u32 m0, s71, 106496
    s_add_u32 s67, s74, 1024
    buffer_load_dwordx4 v154, s[40:43], s67 offen lds
    buffer_load_dwordx4 v155, s[40:43], s67 offen offset:1024 lds
    ds_read_b64_tr_b16 v[76:77], v10 offset:20480
    ds_read_b64_tr_b16 v[78:79], v10 offset:20992
    s_waitcnt lgkmcnt(2)
    v_mfma_f32_32x32x16_bf16 v[32:47], v[72:75], v[64:67], v[32:47]
    ds_read_b64_tr_b16 v[68:69], v10 offset:45056
    ds_read_b64_tr_b16 v[70:71], v10 offset:45568
    s_waitcnt lgkmcnt(2)
    v_mfma_f32_32x32x16_bf16 v[48:63], v[64:67], v[76:79], v[48:63]
    s_waitcnt vmcnt(4)
    ds_write_b32 v158, v159
    ds_read_b128 v[80:83], v5 offset:8192
    ds_read_b64_tr_b16 v[88:89], v10 offset:6144
    ds_read_b64_tr_b16 v[90:91], v10 offset:6656
    s_waitcnt lgkmcnt(4)
    v_mfma_f32_32x32x16_bf16 v[16:31], v[68:71], v[64:67], v[16:31]
    s_add_u32 m0, s71, 114688
    s_add_u32 s67, s74, 2048
    buffer_load_dwordx4 v154, s[40:43], s67 offen lds
    buffer_load_dwordx4 v155, s[40:43], s67 offen offset:1024 lds
    ds_read_b64_tr_b16 v[92:93], v10 offset:22528
    ds_read_b64_tr_b16 v[94:95], v10 offset:23040
    s_waitcnt lgkmcnt(2)
    v_mfma_f32_32x32x16_bf16 v[32:47], v[88:91], v[80:83], v[32:47]
    ds_read_b32 v161, v160
    ds_read_b64_tr_b16 v[84:85], v10 offset:47104
    ds_read_b64_tr_b16 v[86:87], v10 offset:47616
    s_waitcnt lgkmcnt(3)
    v_mfma_f32_32x32x16_bf16 v[48:63], v[80:83], v[92:95], v[48:63]
    s_waitcnt lgkmcnt(2)
    s_setprio 3
    v_cmp_gt_u32 vcc, 5, v161
    s_cbranch_vccz L_50
    s_mov_b32 s88, 400000
L_49:
    ds_read_b32 v161, v160 offset:0
    s_waitcnt lgkmcnt(0)
    v_cmp_gt_u32 vcc, 5, v161
    s_cbranch_vccz L_50
    s_sub_u32 s88, s88, 1
    s_cmp_lg_u32 s88, 0
    s_cbranch_scc1 L_49
L_50:
    v_mov_b32 v159, 6
    s_setprio 0
    ds_read_b128 v[96:99], v2 offset:16384
    ds_read_b64_tr_b16 v[104:105], v10 offset:57344
    ds_read_b64_tr_b16 v[106:107], v10 offset:57856
    s_waitcnt lgkmcnt(3)
    v_mfma_f32_32x32x16_bf16 v[16:31], v[84:87], v[80:83], v[16:31]
    s_add_u32 m0, s71, 0
    s_nop 0
    buffer_load_dwordx4 v152, s[36:39], s73 offen lds
    buffer_load_dwordx4 v153, s[36:39], s73 offen offset:1024 lds
    ds_read_b64_tr_b16 v[108:109], v11 offset:0
    ds_read_b64_tr_b16 v[110:111], v11 offset:512
    s_waitcnt lgkmcnt(2)
    v_mfma_f32_32x32x16_bf16 v[32:47], v[104:107], v[96:99], v[32:47]
    ds_read_b64_tr_b16 v[100:101], v10 offset:32768
    ds_read_b64_tr_b16 v[102:103], v10 offset:33280
    s_waitcnt lgkmcnt(2)
    v_mfma_f32_32x32x16_bf16 v[48:63], v[96:99], v[108:111], v[48:63]
    ds_read_b128 v[64:67], v3 offset:16384
    ds_read_b64_tr_b16 v[72:73], v10 offset:59392
    ds_read_b64_tr_b16 v[74:75], v10 offset:59904
    s_waitcnt lgkmcnt(3)
    v_mfma_f32_32x32x16_bf16 v[16:31], v[100:103], v[96:99], v[16:31]
    s_add_u32 s73, s72, 512
    s_and_b32 s73, s73, 1023
    s_mul_i32 s74, s73, 1536
    s_add_u32 m0, s71, 73728
    s_add_u32 s67, s74, 0
    buffer_load_dwordx4 v154, s[40:43], s67 offen lds
    buffer_load_dwordx4 v155, s[40:43], s67 offen offset:1024 lds
    ds_read_b64_tr_b16 v[76:77], v11 offset:2048
    ds_read_b64_tr_b16 v[78:79], v11 offset:2560
    s_waitcnt lgkmcnt(2)
    v_mfma_f32_32x32x16_bf16 v[32:47], v[72:75], v[64:67], v[32:47]
    ds_read_b64_tr_b16 v[68:69], v10 offset:34816
    ds_read_b64_tr_b16 v[70:71], v10 offset:35328
    s_waitcnt lgkmcnt(2)
    v_mfma_f32_32x32x16_bf16 v[48:63], v[64:67], v[76:79], v[48:63]
    ds_read_b128 v[80:83], v4 offset:16384
    ds_read_b64_tr_b16 v[88:89], v10 offset:61440
    ds_read_b64_tr_b16 v[90:91], v10 offset:61952
    s_waitcnt lgkmcnt(3)
    v_mfma_f32_32x32x16_bf16 v[16:31], v[68:71], v[64:67], v[16:31]
    s_add_u32 m0, s71, 32768
    s_add_u32 s67, s74, 1024
    buffer_load_dwordx4 v154, s[40:43], s67 offen lds
    buffer_load_dwordx4 v155, s[40:43], s67 offen offset:1024 lds
    ds_read_b64_tr_b16 v[92:93], v11 offset:4096
    ds_read_b64_tr_b16 v[94:95], v11 offset:4608
    s_waitcnt lgkmcnt(2)
    v_mfma_f32_32x32x16_bf16 v[32:47], v[88:91], v[80:83], v[32:47]
    ds_read_b64_tr_b16 v[84:85], v10 offset:36864
    ds_read_b64_tr_b16 v[86:87], v10 offset:37376
    s_waitcnt lgkmcnt(2)
    v_mfma_f32_32x32x16_bf16 v[48:63], v[80:83], v[92:95], v[48:63]
    s_waitcnt vmcnt(4)
    ds_write_b32 v158, v159
    ds_read_b128 v[96:99], v5 offset:16384
    ds_read_b64_tr_b16 v[104:105], v10 offset:63488
    ds_read_b64_tr_b16 v[106:107], v10 offset:64000
    s_waitcnt lgkmcnt(4)
    v_mfma_f32_32x32x16_bf16 v[16:31], v[84:87], v[80:83], v[16:31]
    s_add_u32 m0, s71, 49152
    s_add_u32 s67, s74, 2048
    buffer_load_dwordx4 v154, s[40:43], s67 offen lds
    buffer_load_dwordx4 v155, s[40:43], s67 offen offset:1024 lds
    ds_read_b64_tr_b16 v[108:109], v11 offset:6144
    ds_read_b64_tr_b16 v[110:111], v11 offset:6656
    s_waitcnt lgkmcnt(2)
    v_mfma_f32_32x32x16_bf16 v[32:47], v[104:107], v[96:99], v[32:47]
    ds_read_b32 v161, v160
    ds_read_b64_tr_b16 v[100:101], v10 offset:38912
    ds_read_b64_tr_b16 v[102:103], v10 offset:39424
    s_waitcnt lgkmcnt(3)
    v_mfma_f32_32x32x16_bf16 v[48:63], v[96:99], v[108:111], v[48:63]
    s_waitcnt lgkmcnt(2)
    s_setprio 3
    v_cmp_gt_u32 vcc, 6, v161
    s_cbranch_vccz L_52
    s_mov_b32 s88, 400000
L_51:
    ds_read_b32 v161, v160 offset:0
    s_waitcnt lgkmcnt(0)
    v_cmp_gt_u32 vcc, 6, v161
    s_cbranch_vccz L_52
    s_sub_u32 s88, s88, 1
    s_cmp_lg_u32 s88, 0
    s_cbranch_scc1 L_51
L_52:
    v_mov_b32 v159, 7
    s_setprio 0
    ds_read_b128 v[64:67], v2 offset:0
    ds_read_b64_tr_b16 v[72:73], v11 offset:16384
    ds_read_b64_tr_b16 v[74:75], v11 offset:16896
    s_waitcnt lgkmcnt(3)
    v_mfma_f32_32x32x16_bf16 v[16:31], v[100:103], v[96:99], v[16:31]
    s_add_u32 m0, s71, 8192
    s_nop 0
    buffer_load_dwordx4 v152, s[36:39], s73 offen lds
    buffer_load_dwordx4 v153, s[36:39], s73 offen offset:1024 lds
    ds_read_b64_tr_b16 v[76:77], v11 offset:24576
    ds_read_b64_tr_b16 v[78:79], v11 offset:25088
    s_waitcnt lgkmcnt(2)
    v_mfma_f32_32x32x16_bf16 v[32:47], v[72:75], v[64:67], v[32:47]
    ds_read_b64_tr_b16 v[68:69], v11 offset:8192
    ds_read_b64_tr_b16 v[70:71], v11 offset:8704
    s_waitcnt lgkmcnt(2)
    v_mfma_f32_32x32x16_bf16 v[48:63], v[64:67], v[76:79], v[48:63]
    ds_read_b128 v[80:83], v3 offset:0
    ds_read_b64_tr_b16 v[88:89], v11 offset:18432
    ds_read_b64_tr_b16 v[90:91], v11 offset:18944
    s_waitcnt lgkmcnt(3)
    v_mfma_f32_32x32x16_bf16 v[16:31], v[68:71], v[64:67], v[16:31]
    s_add_u32 s73, s72, 640
    s_and_b32 s73, s73, 1023
    s_mul_i32 s74, s73, 1536
    s_add_u32 m0, s71, 65536
    s_add_u32 s67, s74, 0
    buffer_load_dwordx4 v154, s[40:43], s67 offen lds
    buffer_load_dwordx4 v155, s[40:43], s67 offen offset:1024 lds
    ds_read_b64_tr_b16 v[92:93], v11 offset:26624
    ds_read_b64_tr_b16 v[94:95], v11 offset:27136
    s_waitcnt lgkmcnt(2)
    v_mfma_f32_32x32x16_bf16 v[32:47], v[88:91], v[80:83], v[32:47]
    ds_read_b64_tr_b16 v[84:85], v11 offset:10240
    ds_read_b64_tr_b16 v[86:87], v11 offset:10752
    s_waitcnt lgkmcnt(2)
    v_mfma_f32_32x32x16_bf16 v[48:63], v[80:83], v[92:95], v[48:63]
    ds_read_b128 v[96:99], v4 offset:0
    ds_read_b64_tr_b16 v[104:105], v11 offset:20480
    ds_read_b64_tr_b16 v[106:107], v11 offset:20992
    s_waitcnt lgkmcnt(3)
    v_mfma_f32_32x32x16_bf16 v[16:31], v[84:87], v[80:83], v[16:31]
    s_add_u32 m0, s71, 24576
    s_add_u32 s67, s74, 1024
    buffer_load_dwordx4 v154, s[40:43], s67 offen lds
    buffer_load_dwordx4 v155, s[40:43], s67 offen offset:1024 lds
    ds_read_b64_tr_b16 v[108:109], v11 offset:28672
    ds_read_b64_tr_b16 v[110:111], v11 offset:29184
    s_waitcnt lgkmcnt(2)
    v_mfma_f32_32x32x16_bf16 v[32:47], v[104:107], v[96:99], v[32:47]
    ds_read_b64_tr_b16 v[100:101], v11 offset:12288
    ds_read_b64_tr_b16 v[102:103], v11 offset:12800
    s_waitcnt lgkmcnt(2)
    v_mfma_f32_32x32x16_bf16 v[48:63], v[96:99], v[108:111], v[48:63]
    s_waitcnt vmcnt(4)
    ds_write_b32 v158, v159
    ds_read_b128 v[64:67], v5 offset:0
    ds_read_b64_tr_b16 v[72:73], v11 offset:22528
    ds_read_b64_tr_b16 v[74:75], v11 offset:23040
    s_waitcnt lgkmcnt(4)
    v_mfma_f32_32x32x16_bf16 v[16:31], v[100:103], v[96:99], v[16:31]
    s_add_u32 m0, s71, 40960
    s_add_u32 s67, s74, 2048
    buffer_load_dwordx4 v154, s[40:43], s67 offen lds
    buffer_load_dwordx4 v155, s[40:43], s67 offen offset:1024 lds
    ds_read_b64_tr_b16 v[76:77], v11 offset:30720
    ds_read_b64_tr_b16 v[78:79], v11 offset:31232
    s_waitcnt lgkmcnt(2)
    v_mfma_f32_32x32x16_bf16 v[32:47], v[72:75], v[64:67], v[32:47]
    ds_read_b32 v161, v160
    ds_read_b64_tr_b16 v[68:69], v11 offset:14336
    ds_read_b64_tr_b16 v[70:71], v11 offset:14848
    s_waitcnt lgkmcnt(3)
    v_mfma_f32_32x32x16_bf16 v[48:63], v[64:67], v[76:79], v[48:63]
    s_waitcnt lgkmcnt(2)
    s_setprio 3
    v_cmp_gt_u32 vcc, 7, v161
    s_cbranch_vccz L_54
    s_mov_b32 s88, 400000
L_53:
    ds_read_b32 v161, v160 offset:0
    s_waitcnt lgkmcnt(0)
    v_cmp_gt_u32 vcc, 7, v161
    s_cbranch_vccz L_54
    s_sub_u32 s88, s88, 1
    s_cmp_lg_u32 s88, 0
    s_cbranch_scc1 L_53
L_54:
    v_mov_b32 v159, 8
    s_setprio 0
    ds_read_b128 v[80:83], v2 offset:8192
    ds_read_b64_tr_b16 v[88:89], v10 offset:8192
    ds_read_b64_tr_b16 v[90:91], v10 offset:8704
    s_waitcnt lgkmcnt(3)
    v_mfma_f32_32x32x16_bf16 v[16:31], v[68:71], v[64:67], v[16:31]
    s_add_u32 m0, s71, 16384
    s_nop 0
    buffer_load_dwordx4 v152, s[36:39], s73 offen lds
    buffer_load_dwordx4 v153, s[36:39], s73 offen offset:1024 lds
    ds_read_b64_tr_b16 v[92:93], v10 offset:24576
    ds_read_b64_tr_b16 v[94:95], v10 offset:25088
    s_waitcnt lgkmcnt(2)
    v_mfma_f32_32x32x16_bf16 v[32:47], v[88:91], v[80:83], v[32:47]
    ds_read_b64_tr_b16 v[84:85], v10 offset:49152
    ds_read_b64_tr_b16 v[86:87], v10 offset:49664
    s_waitcnt lgkmcnt(2)
    v_mfma_f32_32x32x16_bf16 v[48:63], v[80:83], v[92:95], v[48:63]
    ds_read_b128 v[96:99], v3 offset:8192
    ds_read_b64_tr_b16 v[104:105], v10 offset:10240
    ds_read_b64_tr_b16 v[106:107], v10 offset:10752
    s_waitcnt lgkmcnt(3)
    v_mfma_f32_32x32x16_bf16 v[16:31], v[84:87], v[80:83], v[16:31]
    s_add_u32 s73, s72, 768
    s_and_b32 s73, s73, 1023
    s_mul_i32 s74, s73, 1536
    s_add_u32 m0, s71, 57344
    s_add_u32 s67, s74, 0
    buffer_load_dwordx4 v154, s[40:43], s67 offen lds
    buffer_load_dwordx4 v155, s[40:43], s67 offen offset:1024 lds
    ds_read_b64_tr_b16 v[108:109], v10 offset:26624
    ds_read_b64_tr_b16 v[110:111], v10 offset:27136
    s_waitcnt lgkmcnt(2)
    v_mfma_f32_32x32x16_bf16 v[32:47], v[104:107], v[96:99], v[32:47]
    ds_read_b64_tr_b16 v[100:101], v10 offset:51200
    ds_read_b64_tr_b16 v[102:103], v10 offset:51712
    s_waitcnt lgkmcnt(2)
    v_mfma_f32_32x32x16_bf16 v[48:63], v[96:99], v[108:111], v[48:63]
    ds_read_b128 v[64:67], v4 offset:8192
    ds_read_b64_tr_b16 v[72:73], v10 offset:12288
    ds_read_b64_tr_b16 v[74:75], v10 offset:12800
    s_waitcnt lgkmcnt(3)
    v_mfma_f32_32x32x16_bf16 v[16:31], v[100:103], v[96:99], v[16:31]
    s_add_u32 m0, s71, 81920
    s_add_u32 s67, s74, 1024
    buffer_load_dwordx4 v154, s[40:43], s67 offen lds
    buffer_load_dwordx4 v155, s[40:43], s67 offen offset:1024 lds
    ds_read_b64_tr_b16 v[76:77], v10 offset:28672
    ds_read_b64_tr_b16 v[78:79], v10 offset:29184
    s_waitcnt lgkmcnt(2)
    v_mfma_f32_32x32x16_bf16 v[32:47], v[72:75], v[64:67], v[32:47]
    ds_read_b64_tr_b16 v[68:69], v10 offset:53248
    ds_read_b64_tr_b16 v[70:71], v10 offset:53760
    s_waitcnt lgkmcnt(2)
    v_mfma_f32_32x32x16_bf16 v[48:63], v[64:67], v[76:79], v[48:63]
    s_waitcnt vmcnt(4)
    ds_write_b32 v158, v159
    ds_read_b128 v[80:83], v5 offset:8192
    ds_read_b64_tr_b16 v[88:89], v10 offset:14336
    ds_read_b64_tr_b16 v[90:91], v10 offset:14848
    s_waitcnt lgkmcnt(4)
    v_mfma_f32_32x32x16_bf16 v[16:31], v[68:71], v[64:67], v[16:31]
    s_add_u32 m0, s71, 90112
    s_add_u32 s67, s74, 2048
    buffer_load_dwordx4 v154, s[40:43], s67 offen lds
    buffer_load_dwordx4 v155, s[40:43], s67 offen offset:1024 lds
    ds_read_b64_tr_b16 v[92:93], v10 offset:30720
    ds_read_b64_tr_b16 v[94:95], v10 offset:31232
    s_waitcnt lgkmcnt(2)
    v_mfma_f32_32x32x16_bf16 v[32:47], v[88:91], v[80:83], v[32:47]
    ds_read_b32 v161, v160
    ds_read_b64_tr_b16 v[84:85], v10 offset:55296
    ds_read_b64_tr_b16 v[86:87], v10 offset:55808
    s_waitcnt lgkmcnt(3)
    v_mfma_f32_32x32x16_bf16 v[48:63], v[80:83], v[92:95], v[48:63]
    s_waitcnt lgkmcnt(2)
    s_setprio 3
    v_cmp_gt_u32 vcc, 8, v161
    s_cbranch_vccz L_56
    s_mov_b32 s88, 400000
L_55:
    ds_read_b32 v161, v160 offset:0
    s_waitcnt lgkmcnt(0)
    v_cmp_gt_u32 vcc, 8, v161
    s_cbranch_vccz L_56
    s_sub_u32 s88, s88, 1
    s_cmp_lg_u32 s88, 0
    s_cbranch_scc1 L_55
L_56:
    v_mov_b32 v159, 9
    s_setprio 0
    ds_read_b128 v[96:99], v2 offset:16384
    ds_read_b64_tr_b16 v[104:105], v10 offset:0
    ds_read_b64_tr_b16 v[106:107], v10 offset:512
    s_waitcnt lgkmcnt(3)
    v_mfma_f32_32x32x16_bf16 v[16:31], v[84:87], v[80:83], v[16:31]
    s_add_u32 m0, s71, 0
    s_nop 0
    buffer_load_dwordx4 v152, s[36:39], s73 offen lds
    buffer_load_dwordx4 v153, s[36:39], s73 offen offset:1024 lds
    ds_read_b64_tr_b16 v[108:109], v10 offset:16384
    ds_read_b64_tr_b16 v[110:111], v10 offset:16896
    s_waitcnt lgkmcnt(2)
    v_mfma_f32_32x32x16_bf16 v[32:47], v[104:107], v[96:99], v[32:47]
    ds_read_b64_tr_b16 v[100:101], v10 offset:40960
    ds_read_b64_tr_b16 v[102:103], v10 offset:41472
    s_waitcnt lgkmcnt(2)
    v_mfma_f32_32x32x16_bf16 v[48:63], v[96:99], v[108:111], v[48:63]
    ds_read_b128 v[64:67], v3 offset:16384
    ds_read_b64_tr_b16 v[72:73], v10 offset:2048
    ds_read_b64_tr_b16 v[74:75], v10 offset:2560
    s_waitcnt lgkmcnt(3)
    v_mfma_f32_32x32x16_bf16 v[16:31], v[100:103], v[96:99], v[16:31]
    s_add_u32 s73, s72, 896
    s_and_b32 s73, s73, 1023
    s_mul_i32 s74, s73, 1536
    s_add_u32 m0, s71, 98304
    s_add_u32 s67, s74, 0
    buffer_load_dwordx4 v154, s[40:43], s67 offen lds
    buffer_load_dwordx4 v155, s[40:43], s67 offen offset:1024 lds
    ds_read_b64_tr_b16 v[76:77], v10 offset:18432
    ds_read_b64_tr_b16 v[78:79], v10 offset:18944
    s_waitcnt lgkmcnt(2)
    v_mfma_f32_32x32x16_bf16 v[32:47], v[72:75], v[64:67], v[32:47]
    ds_read_b64_tr_b16 v[68:69], v10 offset:43008
    ds_read_b64_tr_b16 v[70:71], v10 offset:43520
    s_waitcnt lgkmcnt(2)
    v_mfma_f32_32x32x16_bf16 v[48:63], v[64:67], v[76:79], v[48:63]
    ds_read_b128 v[80:83], v4 offset:16384
    ds_read_b64_tr_b16 v[88:89], v10 offset:4096
    ds_read_b64_tr_b16 v[90:91], v10 offset:4608
    s_waitcnt lgkmcnt(3)
    v_mfma_f32_32x32x16_bf16 v[16:31], v[68:71], v[64:67], v[16:31]
    s_add_u32 m0, s71, 106496
    s_add_u32 s67, s74, 1024
    buffer_load_dwordx4 v154, s[40:43], s67 offen lds
    buffer_load_dwordx4 v155, s[40:43], s67 offen offset:1024 lds
    ds_read_b64_tr_b16 v[92:93], v10 offset:20480
    ds_read_b64_tr_b16 v[94:95], v10 offset:20992
    s_waitcnt lgkmcnt(2)
    v_mfma_f32_32x32x16_bf16 v[32:47], v[88:91], v[80:83], v[32:47]
    ds_read_b64_tr_b16 v[84:85], v10 offset:45056
    ds_read_b64_tr_b16 v[86:87], v10 offset:45568
    s_waitcnt lgkmcnt(2)
    v_mfma_f32_32x32x16_bf16 v[48:63], v[80:83], v[92:95], v[48:63]
    s_waitcnt vmcnt(4)
    ds_write_b32 v158, v159
    ds_read_b128 v[96:99], v5 offset:16384
    ds_read_b64_tr_b16 v[104:105], v10 offset:6144
    ds_read_b64_tr_b16 v[106:107], v10 offset:6656
    s_waitcnt lgkmcnt(4)
    v_mfma_f32_32x32x16_bf16 v[16:31], v[84:87], v[80:83], v[16:31]
    s_add_u32 m0, s71, 114688
    s_add_u32 s67, s74, 2048
    buffer_load_dwordx4 v154, s[40:43], s67 offen lds
    buffer_load_dwordx4 v155, s[40:43], s67 offen offset:1024 lds
    ds_read_b64_tr_b16 v[108:109], v10 offset:22528
    ds_read_b64_tr_b16 v[110:111], v10 offset:23040
    s_waitcnt lgkmcnt(2)
    v_mfma_f32_32x32x16_bf16 v[32:47], v[104:107], v[96:99], v[32:47]
    ds_read_b32 v161, v160
    ds_read_b64_tr_b16 v[100:101], v10 offset:47104
    ds_read_b64_tr_b16 v[102:103], v10 offset:47616
    s_waitcnt lgkmcnt(3)
    v_mfma_f32_32x32x16_bf16 v[48:63], v[96:99], v[108:111], v[48:63]
    s_waitcnt lgkmcnt(2)
    s_setprio 3
    v_cmp_gt_u32 vcc, 9, v161
    s_cbranch_vccz L_58
    s_mov_b32 s88, 400000
L_57:
    ds_read_b32 v161, v160 offset:0
    s_waitcnt lgkmcnt(0)
    v_cmp_gt_u32 vcc, 9, v161
    s_cbranch_vccz L_58
    s_sub_u32 s88, s88, 1
    s_cmp_lg_u32 s88, 0
    s_cbranch_scc1 L_57
L_58:
    v_mov_b32 v159, 10
    s_setprio 0
    ds_read_b128 v[64:67], v2 offset:0
    ds_read_b64_tr_b16 v[72:73], v10 offset:57344
    ds_read_b64_tr_b16 v[74:75], v10 offset:57856
    s_waitcnt lgkmcnt(3)
    v_mfma_f32_32x32x16_bf16 v[16:31], v[100:103], v[96:99], v[16:31]
    s_add_u32 m0, s71, 8192
    s_nop 0
    buffer_load_dwordx4 v152, s[36:39], s73 offen lds
    buffer_load_dwordx4 v153, s[36:39], s73 offen offset:1024 lds
    ds_read_b64_tr_b16 v[76:77], v11 offset:0
    ds_read_b64_tr_b16 v[78:79], v11 offset:512
    s_waitcnt lgkmcnt(2)
    v_mfma_f32_32x32x16_bf16 v[32:47], v[72:75], v[64:67], v[32:47]
    ds_read_b64_tr_b16 v[68:69], v10 offset:32768
    ds_read_b64_tr_b16 v[70:71], v10 offset:33280
    s_waitcnt lgkmcnt(2)
    v_mfma_f32_32x32x16_bf16 v[48:63], v[64:67], v[76:79], v[48:63]
    ds_read_b128 v[80:83], v3 offset:0
    ds_read_b64_tr_b16 v[88:89], v10 offset:59392
    ds_read_b64_tr_b16 v[90:91], v10 offset:59904
    s_waitcnt lgkmcnt(3)
    v_mfma_f32_32x32x16_bf16 v[16:31], v[68:71], v[64:67], v[16:31]
    s_add_u32 m0, s71, 32768
    s_add_u32 s67, s84, 262144
    s_and_b32 s67, s67, 0x7ffff
    buffer_load_dwordx4 v166, s[44:47], s67 offen lds
    buffer_load_dwordx4 v167, s[44:47], s67 offen offset:1024 lds
    ds_read_b64_tr_b16 v[92:93], v11 offset:2048
    ds_read_b64_tr_b16 v[94:95], v11 offset:2560
    s_waitcnt lgkmcnt(2)
    v_mfma_f32_32x32x16_bf16 v[32:47], v[88:91], v[80:83], v[32:47]
    ds_read_b64_tr_b16 v[84:85], v10 offset:34816
    ds_read_b64_tr_b16 v[86:87], v10 offset:35328
    s_waitcnt lgkmcnt(2)
    v_mfma_f32_32x32x16_bf16 v[48:63], v[80:83], v[92:95], v[48:63]
    ds_read_b128 v[96:99], v4 offset:0
    ds_read_b64_tr_b16 v[104:105], v10 offset:61440
    ds_read_b64_tr_b16 v[106:107], v10 offset:61952
    s_waitcnt lgkmcnt(3)
    v_mfma_f32_32x32x16_bf16 v[16:31], v[84:87], v[80:83], v[16:31]
    s_add_u32 m0, s71, 73728
    s_add_u32 s67, s84, 131072
    s_and_b32 s67, s67, 0x7ffff
    buffer_load_dwordx4 v166, s[32:35], s67 offen lds
    buffer_load_dwordx4 v167, s[32:35], s67 offen offset:1024 lds
    ds_read_b64_tr_b16 v[108:109], v11 offset:4096
    ds_read_b64_tr_b16 v[110:111], v11 offset:4608
    s_waitcnt lgkmcnt(2)
    v_mfma_f32_32x32x16_bf16 v[32:47], v[104:107], v[96:99], v[32:47]
    ds_read_b64_tr_b16 v[100:101], v10 offset:36864
    ds_read_b64_tr_b16 v[102:103], v10 offset:37376
    s_waitcnt lgkmcnt(2)
    v_mfma_f32_32x32x16_bf16 v[48:63], v[96:99], v[108:111], v[48:63]
    s_waitcnt vmcnt(4)
    ds_write_b32 v158, v159
    ds_read_b128 v[64:67], v5 offset:0
    ds_read_b64_tr_b16 v[72:73], v10 offset:63488
    ds_read_b64_tr_b16 v[74:75], v10 offset:64000
    s_waitcnt lgkmcnt(4)
    v_mfma_f32_32x32x16_bf16 v[16:31], v[100:103], v[96:99], v[16:31]
    s_add_u32 m0, s71, 49152
    s_add_u32 s67, s84, 393216
    s_and_b32 s67, s67, 0x7ffff
    buffer_load_dwordx4 v166, s[44:47], s67 offen lds
    buffer_load_dwordx4 v167, s[44:47], s67 offen offset:1024 lds
    ds_read_b64_tr_b16 v[76:77], v11 offset:6144
    ds_read_b64_tr_b16 v[78:79], v11 offset:6656
    s_waitcnt lgkmcnt(2)
    v_mfma_f32_32x32x16_bf16 v[32:47], v[72:75], v[64:67], v[32:47]
    ds_read_b32 v161, v160
    ds_read_b64_tr_b16 v[68:69], v10 offset:38912
    ds_read_b64_tr_b16 v[70:71], v10 offset:39424
    s_waitcnt lgkmcnt(3)
    v_mfma_f32_32x32x16_bf16 v[48:63], v[64:67], v[76:79], v[48:63]
    s_waitcnt lgkmcnt(2)
    s_setprio 3
    v_cmp_gt_u32 vcc, 10, v161
    s_cbranch_vccz L_60
    s_mov_b32 s88, 400000
L_59:
    ds_read_b32 v161, v160 offset:0
    s_waitcnt lgkmcnt(0)
    v_cmp_gt_u32 vcc, 10, v161
    s_cbranch_vccz L_60
    s_sub_u32 s88, s88, 1
    s_cmp_lg_u32 s88, 0
    s_cbranch_scc1 L_59
L_60:
    v_mov_b32 v159, 11
    s_setprio 0
    ds_read_b128 v[80:83], v2 offset:8192
    ds_read_b64_tr_b16 v[88:89], v11 offset:16384
    ds_read_b64_tr_b16 v[90:91], v11 offset:16896
    s_waitcnt lgkmcnt(3)
    v_mfma_f32_32x32x16_bf16 v[16:31], v[68:71], v[64:67], v[16:31]
    ds_read_b64_tr_b16 v[92:93], v11 offset:24576
    ds_read_b64_tr_b16 v[94:95], v11 offset:25088
    s_waitcnt lgkmcnt(2)
    v_mfma_f32_32x32x16_bf16 v[32:47], v[88:91], v[80:83], v[32:47]
    buffer_load_dword v151, v150, s[56:59], 0 offen sc1
    ds_read_b64_tr_b16 v[84:85], v11 offset:8192
    ds_read_b64_tr_b16 v[86:87], v11 offset:8704
    s_waitcnt lgkmcnt(2)
    v_mfma_f32_32x32x16_bf16 v[48:63], v[80:83], v[92:95], v[48:63]
    ds_read_b128 v[96:99], v3 offset:8192
    ds_read_b64_tr_b16 v[104:105], v11 offset:18432
    ds_read_b64_tr_b16 v[106:107], v11 offset:18944
    s_waitcnt lgkmcnt(3)
    v_mfma_f32_32x32x16_bf16 v[16:31], v[84:87], v[80:83], v[16:31]
    s_add_u32 m0, s71, 24576
    s_add_u32 s67, s84, 196608
    s_and_b32 s67, s67, 0x7ffff
    buffer_load_dwordx4 v166, s[44:47], s67 offen lds
    buffer_load_dwordx4 v167, s[44:47], s67 offen offset:1024 lds
    ds_read_b64_tr_b16 v[108:109], v11 offset:26624
    ds_read_b64_tr_b16 v[110:111], v11 offset:27136
    s_waitcnt lgkmcnt(2)
    v_mfma_f32_32x32x16_bf16 v[32:47], v[104:107], v[96:99], v[32:47]
    ds_read_b64_tr_b16 v[100:101], v11 offset:10240
    ds_read_b64_tr_b16 v[102:103], v11 offset:10752
    s_waitcnt lgkmcnt(2)
    v_mfma_f32_32x32x16_bf16 v[48:63], v[96:99], v[108:111], v[48:63]
    ds_read_b128 v[64:67], v4 offset:8192
    ds_read_b64_tr_b16 v[72:73], v11 offset:20480
    ds_read_b64_tr_b16 v[74:75], v11 offset:20992
    s_waitcnt lgkmcnt(3)
    v_mfma_f32_32x32x16_bf16 v[16:31], v[100:103], v[96:99], v[16:31]
    s_add_u32 m0, s71, 65536
    s_add_u32 s67, s84, 65536
    s_and_b32 s67, s67, 0x7ffff
    buffer_load_dwordx4 v166, s[32:35], s67 offen lds
    buffer_load_dwordx4 v167, s[32:35], s67 offen offset:1024 lds
    ds_read_b64_tr_b16 v[76:77], v11 offset:28672
    ds_read_b64_tr_b16 v[78:79], v11 offset:29184
    s_waitcnt lgkmcnt(2)
    v_mfma_f32_32x32x16_bf16 v[32:47], v[72:75], v[64:67], v[32:47]
    ds_read_b64_tr_b16 v[68:69], v11 offset:12288
    ds_read_b64_tr_b16 v[70:71], v11 offset:12800
    s_waitcnt lgkmcnt(2)
    v_mfma_f32_32x32x16_bf16 v[48:63], v[64:67], v[76:79], v[48:63]
    ds_read_b128 v[80:83], v5 offset:8192
    ds_read_b64_tr_b16 v[88:89], v11 offset:22528
    ds_read_b64_tr_b16 v[90:91], v11 offset:23040
    s_waitcnt lgkmcnt(3)
    v_mfma_f32_32x32x16_bf16 v[16:31], v[68:71], v[64:67], v[16:31]
    s_add_u32 m0, s71, 40960
    s_add_u32 s67, s84, 327680
    s_and_b32 s67, s67, 0x7ffff
    buffer_load_dwordx4 v166, s[44:47], s67 offen lds
    buffer_load_dwordx4 v167, s[44:47], s67 offen offset:1024 lds
    ds_read_b64_tr_b16 v[92:93], v11 offset:30720
    ds_read_b64_tr_b16 v[94:95], v11 offset:31232
    s_waitcnt lgkmcnt(2)
    v_mfma_f32_32x32x16_bf16 v[32:47], v[88:91], v[80:83], v[32:47]
    ds_read_b64_tr_b16 v[84:85], v11 offset:14336
    ds_read_b64_tr_b16 v[86:87], v11 offset:14848
    s_waitcnt lgkmcnt(2)
    v_mfma_f32_32x32x16_bf16 v[48:63], v[80:83], v[92:95], v[48:63]
    s_waitcnt lgkmcnt(0)
    v_mfma_f32_32x32x16_bf16 v[16:31], v[84:87], v[80:83], v[16:31]
    s_setprio 3
    v_mov_b32 v159, 16
    s_waitcnt lgkmcnt(0)
    ds_write_b32 v158, v159
    s_nop 5
    v_cvt_pk_bf16_f32 v88, v32, v33
    v_cvt_pk_bf16_f32 v89, v34, v35
    v_cvt_pk_bf16_f32 v90, v36, v37
    v_cvt_pk_bf16_f32 v91, v38, v39
    v_cvt_pk_bf16_f32 v92, v40, v41
    v_cvt_pk_bf16_f32 v93, v42, v43
    v_cvt_pk_bf16_f32 v94, v44, v45
    v_cvt_pk_bf16_f32 v95, v46, v47
    v_min_u32 v88, -2, v88
    v_min_u32 v89, -2, v89
    v_min_u32 v90, -2, v90
    v_min_u32 v91, -2, v91
    v_min_u32 v92, -2, v92
    v_min_u32 v93, -2, v93
    v_min_u32 v94, -2, v94
    v_min_u32 v95, -2, v95
    s_mov_b32 exec_lo, 0xff000000
    s_mov_b32 exec_hi, 0xff000000
    buffer_store_dwordx4 v[88:91], v156, s[56:59], s101 offen sc1
    buffer_store_dwordx4 v[92:95], v156, s[56:59], s101 offen offset:256 sc1
    s_mov_b64 exec, -1
    v_cvt_pk_bf16_f32 v104, v48, v49
    v_cvt_pk_bf16_f32 v105, v50, v51
    v_cvt_pk_bf16_f32 v106, v52, v53
    v_cvt_pk_bf16_f32 v107, v54, v55
    v_cvt_pk_bf16_f32 v108, v56, v57
    v_cvt_pk_bf16_f32 v109, v58, v59
    v_cvt_pk_bf16_f32 v110, v60, v61
    v_cvt_pk_bf16_f32 v111, v62, v63
    v_min_u32 v110, -2, v110
    v_min_u32 v111, -2, v111
    buffer_store_dwordx2 v[110:111], v157, s[56:59], s101 offen offset:512 sc1
    s_xor_b32 s68, s64, 0x10000
    buffer_store_dwordx4 v[112:115], v13, s[56:59], s64 offen sc1
    buffer_store_dwordx4 v[112:115], v13, s[56:59], s68 offen sc1
    v_cvt_pk_bf16_f32 v80, v16, v17
    v_cvt_pk_bf16_f32 v81, v18, v19
    v_cvt_pk_bf16_f32 v82, v20, v21
    v_cvt_pk_bf16_f32 v83, v22, v23
    v_cvt_pk_bf16_f32 v84, v24, v25
    v_cvt_pk_bf16_f32 v85, v26, v27
    v_cvt_pk_bf16_f32 v86, v28, v29
    v_cvt_pk_bf16_f32 v87, v30, v31
    s_mov_b32 s88, 400000
L_61:
    ds_read_b32 v161, v160 offset:0
    s_waitcnt lgkmcnt(0)
    v_cmp_gt_u32 vcc, 16, v161
    s_cbranch_vccz L_62
    s_sub_u32 s88, s88, 1
    s_cmp_lg_u32 s88, 0
    s_cbranch_scc1 L_61
L_62:
    v_mfma_f32_32x32x16_bf16 v[16:31], v[88:91], v[80:83], v[124:139]
    v_mfma_f32_32x32x16_bf16 v[32:47], v[92:95], v[84:87], v[124:139]
    s_add_u32 m0, s71, 0
    s_add_u32 s67, s84, 0
    s_and_b32 s67, s67, 0x7ffff
    buffer_load_dwordx4 v166, s[44:47], s67 offen lds
    buffer_load_dwordx4 v167, s[44:47], s67 offen offset:1024 lds
    s_waitcnt vmcnt(2)
    s_add_u32 m0, s71, 8192
    s_add_u32 s67, s84, 65536
    s_and_b32 s67, s67, 0x7ffff
    buffer_load_dwordx4 v166, s[44:47], s67 offen lds
    buffer_load_dwordx4 v167, s[44:47], s67 offen offset:1024 lds
    s_waitcnt vmcnt(2)
    v_max3_f32 v2, v16, v20, v24
    v_max3_f32 v3, v17, v21, v25
    v_max3_f32 v4, v18, v22, v26
    v_max3_f32 v5, v19, v23, v27
    v_max3_f32 v116, v32, v36, v40
    v_max3_f32 v117, v33, v37, v41
    v_max3_f32 v118, v34, v38, v42
    v_max3_f32 v119, v35, v39, v43
    s_sub_u32 s101, s101, 4096
    s_cmp_eq_u32 s61, 0
    s_cselect_b32 s101, 0x80000000, s101
    s_cbranch_scc1 L_63a
    s_mov_b64 exec, 0x1
    s_mov_b32 s88, 400000
    s_branch L_pchk_67
L_poll_65:
    buffer_load_dword v151, v150, s[56:59], 0 offen sc1
L_pchk_67:
    s_waitcnt vmcnt(0)
    v_cmp_ne_u32 vcc, 1, v151
    s_cbranch_vccz L_pdone_66
    s_sleep 12
    s_sub_u32 s88, s88, 1
    s_cmp_lg_u32 s88, 0
    s_cbranch_scc1 L_poll_65
L_pdone_66:
    s_mov_b64 exec, -1
L_63a:
    s_mov_b32 s88, 400000
L_63:
    buffer_load_dwordx4 v[96:99], v156, s[56:59], s101 offen sc1
    buffer_load_dwordx4 v[100:103], v156, s[56:59], s101 offen offset:256 sc1
    buffer_load_dwordx2 v[152:153], v157, s[56:59], s101 offen offset:512 sc1
    s_waitcnt vmcnt(0)
    v_max3_u32 v154, v96, v97, v98
    v_max3_u32 v154, v154, v99, v100
    v_max3_u32 v154, v154, v101, v102
    v_max3_u32 v154, v154, v103, v152
    v_max_u32 v154, v154, v153
    v_cmp_eq_u32 vcc, -1, v154
    s_cbranch_vccz L_64
    s_sleep 12
    s_sub_u32 s88, s88, 1
    s_cmp_lg_u32 s88, 0
    s_cbranch_scc1 L_63
L_64:
    v_mov_b64 v[154:155], 0
    v_mfma_f32_32x32x16_bf16 v[48:63], v[96:99], v[80:83], v[120:135]
    v_mfma_f32_32x32x16_bf16 v[64:79], v[100:103], v[84:87], v[120:135]
    s_add_u32 m0, s71, 16384
    s_add_u32 s67, s84, 131072
    s_and_b32 s67, s67, 0x7ffff
    buffer_load_dwordx4 v166, s[44:47], s67 offen lds
    buffer_load_dwordx4 v167, s[44:47], s67 offen offset:1024 lds
    s_nop 5
    v_max3_f32 v2, v2, v28, v48
    v_max3_f32 v3, v3, v29, v49
    v_max3_f32 v4, v4, v30, v50
    v_max3_f32 v5, v5, v31, v51
    v_max3_f32 v10, v2, v3, v4
    v_max_f32 v10, v10, v5
    v_mov_b32 v11, v10
    v_max3_f32 v116, v116, v44, v64
    v_max3_f32 v117, v117, v45, v65
    v_max3_f32 v118, v118, v46, v66
    v_max3_f32 v119, v119, v47, v67
    v_max3_f32 v150, v116, v117, v118
    v_max_f32 v150, v150, v119
    v_mov_b32 v151, v150
    v_mov_b64 v[58:59], 0
    v_mov_b64 v[74:75], 0
    v_permlane32_swap_b32 v10, v11
    v_permlane32_swap_b32 v150, v151
    s_nop 1
    v_max_f32 v10, v10, v11
    v_mul_f32 v10, s89, v10
    v_fma_f32 v2, v2, s89, -v10
    v_fma_f32 v3, v3, s89, -v10
    v_fma_f32 v4, v4, s89, -v10
    v_fma_f32 v5, v5, s89, -v10
    v_exp_f32 v2, v2
    v_exp_f32 v3, v3
    v_exp_f32 v4, v4
    v_exp_f32 v5, v5
    v_max_f32 v150, v150, v151
    v_mul_f32 v150, s89, v150
    v_fma_f32 v116, v116, s89, -v150
    v_fma_f32 v117, v117, s89, -v150
    v_fma_f32 v118, v118, s89, -v150
    v_fma_f32 v119, v119, s89, -v150
    v_exp_f32 v116, v116
    v_exp_f32 v117, v117
    v_exp_f32 v118, v118
    v_exp_f32 v119, v119
    v_add_f32 v10, v2, v3
    v_add_f32 v11, v4, v5
    v_add_f32 v10, v10, v11
    v_mov_b32 v11, v10
    v_add_f32 v150, v116, v117
    v_add_f32 v151, v118, v119
    v_add_f32 v150, v150, v151
    v_mov_b32 v151, v150
    s_nop 1
    v_permlane32_swap_b32 v10, v11
    v_permlane32_swap_b32 v150, v151
    s_add_u32 m0, s71, 57344
    s_add_u32 s67, s84, 458752
    s_and_b32 s67, s67, 0x7ffff
    buffer_load_dwordx4 v166, s[44:47], s67 offen lds
    buffer_load_dwordx4 v167, s[44:47], s67 offen offset:1024 lds
    v_add_f32 v10, v10, v11
    v_add_f32 v150, v150, v151
    v_rcp_f32 v10, v10
    v_rcp_f32 v150, v150
    s_nop 0
    v_mul_f32 v2, v2, v10
    v_mul_f32 v3, v3, v10
    v_mul_f32 v4, v4, v10
    v_mul_f32 v5, v5, v10
    v_cvt_pk_bf16_f32 v2, v2, v3
    v_cvt_pk_bf16_f32 v3, v4, v5
    v_bfi_b32 v48, v140, 0, v2
    v_bfi_b32 v49, v141, 0, v3
    v_bfi_b32 v50, v142, 0, v2
    v_bfi_b32 v51, v143, 0, v3
    v_bfi_b32 v52, v144, 0, v2
    v_bfi_b32 v53, v145, 0, v3
    v_bfi_b32 v54, v146, 0, v2
    v_bfi_b32 v55, v147, 0, v3
    v_bfi_b32 v56, v148, 0, v2
    v_bfi_b32 v57, v149, 0, v3
    v_mfma_f32_32x32x16_bf16 v[16:31], v[104:107], v[48:51], 0
    v_mfma_f32_32x32x16_bf16 v[16:31], v[108:111], v[52:55], v[16:31]
    v_mfma_f32_32x32x16_bf16 v[16:31], v[152:155], v[56:59], v[16:31]
    v_mul_f32 v116, v116, v150
    v_mul_f32 v117, v117, v150
    v_mul_f32 v118, v118, v150
    v_mul_f32 v119, v119, v150
    v_cvt_pk_bf16_f32 v116, v116, v117
    v_cvt_pk_bf16_f32 v117, v118, v119
    v_bfi_b32 v64, v140, 0, v116
    v_bfi_b32 v65, v141, 0, v117
    v_bfi_b32 v66, v142, 0, v116
    v_bfi_b32 v67, v143, 0, v117
    v_bfi_b32 v68, v144, 0, v116
    v_bfi_b32 v69, v145, 0, v117
    v_bfi_b32 v70, v146, 0, v116
    v_bfi_b32 v71, v147, 0, v117
    v_bfi_b32 v72, v148, 0, v116
    v_bfi_b32 v73, v149, 0, v117
    v_mfma_f32_32x32x16_bf16 v[32:47], v[104:107], v[64:67], 0
    v_mfma_f32_32x32x16_bf16 v[32:47], v[108:111], v[68:71], v[32:47]
    v_mfma_f32_32x32x16_bf16 v[32:47], v[152:155], v[72:75], v[32:47]
    v_cvt_pk_bf16_f32 v80, v16, v17
    v_cvt_pk_bf16_f32 v81, v18, v19
    v_cvt_pk_bf16_f32 v82, v20, v21
    v_cvt_pk_bf16_f32 v83, v22, v23
    buffer_store_dwordx4 v[80:83], v13, s[56:59], s63 offen sc1
    v_xor_b32 v5, 64, v6
    s_lshl_b32 s67, s60, 12
    v_add_u32 v10, s67, v13
    v_xor_b32 v11, 0x2000, v10
    v_add_u32 v10, 122880, v10
    v_add_u32 v11, 122880, v11
    s_nop 1
    v_cvt_pk_bf16_f32 v84, v40, v41
    v_cvt_pk_bf16_f32 v85, v42, v43
    v_cvt_pk_bf16_f32 v86, v44, v45
    v_cvt_pk_bf16_f32 v87, v46, v47
    buffer_store_dwordx4 v[84:87], v13, s[56:59], s63 offen offset:1024 sc1
    s_add_u32 m0, s71, 81920
    s_add_u32 s67, s84, 196608
    s_and_b32 s67, s67, 0x7ffff
    buffer_load_dwordx4 v166, s[32:35], s67 offen lds
    buffer_load_dwordx4 v167, s[32:35], s67 offen offset:1024 lds
    v_mov_b32 v159, 17
    s_waitcnt vmcnt(0)
    ds_write_b32 v158, v159
    s_cmp_lg_u32 s60, 0
    s_cbranch_scc1 L_68
    s_mov_b32 s88, 400000
L_69:
    ds_read_b32 v161, v160 offset:0
    s_waitcnt lgkmcnt(0)
    v_cmp_gt_u32 vcc, 17, v161
    s_cbranch_vccz L_70
    s_sleep 1
    s_sub_u32 s88, s88, 1
    s_cmp_lg_u32 s88, 0
    s_cbranch_scc1 L_69
L_70:
    s_add_u32 s67, s86, 32768
    s_mov_b64 exec, 1
    buffer_store_dword v12, v0, s[56:59], s67 offen sc1
    s_mov_b64 exec, -1
L_68:
    s_add_u32 m0, s71, 90112
    s_add_u32 s67, s84, 262144
    s_and_b32 s67, s67, 0x7ffff
    buffer_load_dwordx4 v166, s[32:35], s67 offen lds
    buffer_load_dwordx4 v167, s[32:35], s67 offen offset:1024 lds
    s_waitcnt vmcnt(2)
    s_add_u32 m0, s71, 98304
    s_add_u32 s67, s84, 327680
    s_and_b32 s67, s67, 0x7ffff
    buffer_load_dwordx4 v166, s[32:35], s67 offen lds
    buffer_load_dwordx4 v167, s[32:35], s67 offen offset:1024 lds
    s_waitcnt vmcnt(2)
    s_add_u32 m0, s71, 106496
    s_add_u32 s67, s84, 393216
    s_and_b32 s67, s67, 0x7ffff
    buffer_load_dwordx4 v166, s[32:35], s67 offen lds
    buffer_load_dwordx4 v167, s[32:35], s67 offen offset:1024 lds
    s_waitcnt vmcnt(2)
    s_add_u32 m0, s71, 114688
    s_add_u32 s67, s84, 458752
    s_and_b32 s67, s67, 0x7ffff
    buffer_load_dwordx4 v166, s[32:35], s67 offen lds
    buffer_load_dwordx4 v167, s[32:35], s67 offen offset:1024 lds
    s_waitcnt vmcnt(2)
    s_mov_b32 s88, 400000
L_71:
    ds_read_b32 v161, v158 offset:64
    s_waitcnt lgkmcnt(0)
    v_cmp_gt_u32 vcc, 1, v161
    s_cbranch_vccz L_72
    s_sleep 8
    s_sub_u32 s88, s88, 1
    s_cmp_lg_u32 s88, 0
    s_cbranch_scc1 L_71
L_72:
    s_mov_b64 exec, 0xf
    s_mov_b32 s88, 400000
L_poll_73:
    buffer_load_dword v3, v8, s[56:59], 0 offen sc1
L_pchk_75:
    s_waitcnt vmcnt(0)
    v_cmp_ne_u32 vcc, 1, v3
    s_cbranch_vccz L_pdone_74
    s_sleep 12
    s_sub_u32 s88, s88, 1
    s_cmp_lg_u32 s88, 0
    s_cbranch_scc1 L_poll_73
L_pdone_74:
    s_mov_b64 exec, -1
    v_mov_b32 v159, 18
    s_waitcnt vmcnt(0)
    ds_write_b32 v158, v159
    s_mov_b32 s88, 400000
L_76:
    ds_read_b32 v161, v160 offset:0
    s_waitcnt lgkmcnt(0)
    v_cmp_gt_u32 vcc, 18, v161
    s_cbranch_vccz L_77
    s_sleep 1
    s_sub_u32 s88, s88, 1
    s_cmp_lg_u32 s88, 0
    s_cbranch_scc1 L_76
L_77:
    buffer_load_dwordx4 v[112:115], v13, s[56:59], s79 offen offset:0 sc1
    buffer_load_dwordx4 v[116:119], v13, s[56:59], s79 offen offset:1024 sc1
    buffer_load_dwordx4 v[120:123], v13, s[56:59], s79 offen offset:2048 sc1
    buffer_load_dwordx4 v[124:127], v13, s[56:59], s79 offen offset:3072 sc1
    buffer_load_dwordx4 v[64:67], v13, s[56:59], s76 offen offset:0 sc1
    buffer_load_dwordx4 v[68:71], v13, s[56:59], s76 offen offset:1024 sc1
    buffer_load_dwordx4 v[72:75], v13, s[56:59], s76 offen offset:2048 sc1
    buffer_load_dwordx4 v[76:79], v13, s[56:59], s76 offen offset:3072 sc1
    s_setprio 0
    ds_read_b64_tr_b16 v[128:129], v6 offset:24576
    ds_read_b64_tr_b16 v[130:131], v6 offset:25600
    ds_read_b64_tr_b16 v[132:133], v5 offset:24576
    ds_read_b64_tr_b16 v[134:135], v5 offset:25600
    ds_read_b64_tr_b16 v[136:137], v6 offset:26624
    ds_read_b64_tr_b16 v[138:139], v6 offset:27648
    ds_read_b64_tr_b16 v[140:141], v5 offset:26624
    ds_read_b64_tr_b16 v[142:143], v5 offset:27648
    ds_read_b64_tr_b16 v[144:145], v6 offset:28672
    ds_read_b64_tr_b16 v[146:147], v6 offset:29696
    ds_read_b64_tr_b16 v[148:149], v5 offset:28672
    ds_read_b64_tr_b16 v[150:151], v5 offset:29696
    s_waitcnt vmcnt(4)
    buffer_load_dwordx4 v[80:83], v13, s[56:59], s77 offen offset:0 sc1
    buffer_load_dwordx4 v[84:87], v13, s[56:59], s77 offen offset:1024 sc1
    buffer_load_dwordx4 v[88:91], v13, s[56:59], s77 offen offset:2048 sc1
    buffer_load_dwordx4 v[92:95], v13, s[56:59], s77 offen offset:3072 sc1
    s_waitcnt lgkmcnt(8)
    v_mfma_f32_32x32x16_bf16 v[48:63], v[132:135], v[112:115], 0
    v_mfma_f32_32x32x16_bf16 v[32:47], v[128:131], v[112:115], 0
    ds_read_b64_tr_b16 v[128:129], v6 offset:30720
    ds_read_b64_tr_b16 v[130:131], v6 offset:31744
    ds_read_b64_tr_b16 v[132:133], v5 offset:30720
    ds_read_b64_tr_b16 v[134:135], v5 offset:31744
    s_waitcnt lgkmcnt(8)
    v_mfma_f32_32x32x16_bf16 v[48:63], v[140:143], v[116:119], v[48:63]
    v_mfma_f32_32x32x16_bf16 v[32:47], v[136:139], v[116:119], v[32:47]
    s_waitcnt lgkmcnt(4)
    v_mfma_f32_32x32x16_bf16 v[48:63], v[148:151], v[120:123], v[48:63]
    v_mfma_f32_32x32x16_bf16 v[32:47], v[144:147], v[120:123], v[32:47]
    s_waitcnt lgkmcnt(0)
    v_mfma_f32_32x32x16_bf16 v[48:63], v[132:135], v[124:127], v[48:63]
    v_mfma_f32_32x32x16_bf16 v[32:47], v[128:131], v[124:127], v[32:47]
    s_waitcnt vmcnt(4)
    buffer_load_dwordx4 v[96:99], v13, s[56:59], s78 offen offset:0 sc1
    buffer_load_dwordx4 v[100:103], v13, s[56:59], s78 offen offset:1024 sc1
    buffer_load_dwordx4 v[104:107], v13, s[56:59], s78 offen offset:2048 sc1
    buffer_load_dwordx4 v[108:111], v13, s[56:59], s78 offen offset:3072 sc1
    s_setprio 3
    v_mov_b32 v159, 19
    s_waitcnt lgkmcnt(0)
    ds_write_b32 v158, v159
    s_mov_b32 s88, 400000
L_78:
    ds_read_b32 v161, v160 offset:0
    s_waitcnt lgkmcnt(0)
    v_cmp_gt_u32 vcc, 19, v161
    s_cbranch_vccz L_79
    s_sub_u32 s88, s88, 1
    s_cmp_lg_u32 s88, 0
    s_cbranch_scc1 L_78
L_79:
    s_add_u32 m0, s71, 57344
    s_add_u32 s67, s84, 0
    s_and_b32 s67, s67, 0x7ffff
    buffer_load_dwordx4 v166, s[32:35], s67 offen lds
    buffer_load_dwordx4 v167, s[32:35], s67 offen offset:1024 lds
    ds_read_b64_tr_b16 v[136:137], v6 offset:0
    ds_read_b64_tr_b16 v[138:139], v6 offset:1024
    ds_read_b64_tr_b16 v[140:141], v5 offset:0
    ds_read_b64_tr_b16 v[142:143], v5 offset:1024
    ds_read_b64_tr_b16 v[144:145], v6 offset:2048
    ds_read_b64_tr_b16 v[146:147], v6 offset:3072
    ds_read_b64_tr_b16 v[148:149], v5 offset:2048
    ds_read_b64_tr_b16 v[150:151], v5 offset:3072
    ds_read_b64_tr_b16 v[128:129], v6 offset:4096
    ds_read_b64_tr_b16 v[130:131], v6 offset:5120
    ds_read_b64_tr_b16 v[132:133], v5 offset:4096
    ds_read_b64_tr_b16 v[134:135], v5 offset:5120
    s_xor_b32 s67, s60, 2
    s_lshl_b32 s67, s67, 12
    s_add_u32 s67, s67, 122880
    v_bfe_u32 v152, v1, 1, 2
    v_lshlrev_b32 v153, 1, v15
    v_xor_b32 v152, v152, v153
    v_lshlrev_b32 v152, 4, v152
    v_lshl_add_u32 v152, v14, 6, v152
    v_add_u32 v152, s67, v152
    v_xor_b32 v153, 16, v152
    v_bfe_u32 v154, v1, 3, 2
    v_lshlrev_b32 v154, 4, v154
    v_xor_b32 v154, v154, v11
    s_sub_u32 s76, s76, 2097152
    s_sub_u32 s77, s77, 2097152
    s_sub_u32 s78, s78, 2097152
    s_sub_u32 s79, s79, 2097152
    s_mov_b32 s88, 400000
    s_setprio 3
    s_waitcnt vmcnt(0)
    s_barrier
    s_waitcnt lgkmcnt(8)
    v_mfma_f32_32x32x16_bf16 v[48:63], v[140:143], v[64:67], v[48:63]
    v_mfma_f32_32x32x16_bf16 v[32:47], v[136:139], v[64:67], v[32:47]
    ds_read_b64_tr_b16 v[136:137], v6 offset:6144
    ds_read_b64_tr_b16 v[138:139], v6 offset:7168
    ds_read_b64_tr_b16 v[140:141], v5 offset:6144
    ds_read_b64_tr_b16 v[142:143], v5 offset:7168
    s_waitcnt lgkmcnt(8)
    v_mfma_f32_32x32x16_bf16 v[48:63], v[148:151], v[68:71], v[48:63]
    v_mfma_f32_32x32x16_bf16 v[32:47], v[144:147], v[68:71], v[32:47]
    ds_read_b64_tr_b16 v[144:145], v6 offset:8192
    ds_read_b64_tr_b16 v[146:147], v6 offset:9216
    ds_read_b64_tr_b16 v[148:149], v5 offset:8192
    ds_read_b64_tr_b16 v[150:151], v5 offset:9216
    s_waitcnt lgkmcnt(8)
    v_mfma_f32_32x32x16_bf16 v[48:63], v[132:135], v[72:75], v[48:63]
    v_mfma_f32_32x32x16_bf16 v[32:47], v[128:131], v[72:75], v[32:47]
    ds_read_b64_tr_b16 v[128:129], v6 offset:10240
    ds_read_b64_tr_b16 v[130:131], v6 offset:11264
    ds_read_b64_tr_b16 v[132:133], v5 offset:10240
    ds_read_b64_tr_b16 v[134:135], v5 offset:11264
    s_waitcnt lgkmcnt(8)
    v_mfma_f32_32x32x16_bf16 v[48:63], v[140:143], v[76:79], v[48:63]
    v_mfma_f32_32x32x16_bf16 v[32:47], v[136:139], v[76:79], v[32:47]
    ds_read_b64_tr_b16 v[136:137], v6 offset:12288
    ds_read_b64_tr_b16 v[138:139], v6 offset:13312
    ds_read_b64_tr_b16 v[140:141], v5 offset:12288
    ds_read_b64_tr_b16 v[142:143], v5 offset:13312
    s_waitcnt lgkmcnt(8)
    v_mfma_f32_32x32x16_bf16 v[48:63], v[148:151], v[80:83], v[48:63]
    v_mfma_f32_32x32x16_bf16 v[32:47], v[144:147], v[80:83], v[32:47]
    ds_read_b64_tr_b16 v[144:145], v6 offset:14336
    ds_read_b64_tr_b16 v[146:147], v6 offset:15360
    ds_read_b64_tr_b16 v[148:149], v5 offset:14336
    ds_read_b64_tr_b16 v[150:151], v5 offset:15360
    s_waitcnt lgkmcnt(8)
    v_mfma_f32_32x32x16_bf16 v[48:63], v[132:135], v[84:87], v[48:63]
    v_mfma_f32_32x32x16_bf16 v[32:47], v[128:131], v[84:87], v[32:47]
    ds_read_b64_tr_b16 v[128:129], v6 offset:16384
    ds_read_b64_tr_b16 v[130:131], v6 offset:17408
    ds_read_b64_tr_b16 v[132:133], v5 offset:16384
    ds_read_b64_tr_b16 v[134:135], v5 offset:17408
    s_waitcnt lgkmcnt(8)
    v_mfma_f32_32x32x16_bf16 v[48:63], v[140:143], v[88:91], v[48:63]
    v_mfma_f32_32x32x16_bf16 v[32:47], v[136:139], v[88:91], v[32:47]
    ds_read_b64_tr_b16 v[136:137], v6 offset:18432
    ds_read_b64_tr_b16 v[138:139], v6 offset:19456
    ds_read_b64_tr_b16 v[140:141], v5 offset:18432
    ds_read_b64_tr_b16 v[142:143], v5 offset:19456
    s_waitcnt lgkmcnt(8)
    v_mfma_f32_32x32x16_bf16 v[48:63], v[148:151], v[92:95], v[48:63]
    v_mfma_f32_32x32x16_bf16 v[32:47], v[144:147], v[92:95], v[32:47]
    ds_read_b64_tr_b16 v[144:145], v6 offset:20480
    ds_read_b64_tr_b16 v[146:147], v6 offset:21504
    ds_read_b64_tr_b16 v[148:149], v5 offset:20480
    ds_read_b64_tr_b16 v[150:151], v5 offset:21504
    s_waitcnt lgkmcnt(8)
    v_mfma_f32_32x32x16_bf16 v[48:63], v[132:135], v[96:99], v[48:63]
    v_mfma_f32_32x32x16_bf16 v[32:47], v[128:131], v[96:99], v[32:47]
    ds_read_b64_tr_b16 v[128:129], v6 offset:22528
    ds_read_b64_tr_b16 v[130:131], v6 offset:23552
    ds_read_b64_tr_b16 v[132:133], v5 offset:22528
    ds_read_b64_tr_b16 v[134:135], v5 offset:23552
    s_waitcnt lgkmcnt(8)
    v_mfma_f32_32x32x16_bf16 v[48:63], v[140:143], v[100:103], v[48:63]
    s_waitcnt lgkmcnt(4)
    v_mfma_f32_32x32x16_bf16 v[48:63], v[148:151], v[104:107], v[48:63]
    s_waitcnt lgkmcnt(0)
    v_mfma_f32_32x32x16_bf16 v[48:63], v[132:135], v[108:111], v[48:63]
    v_mfma_f32_32x32x16_bf16 v[32:47], v[136:139], v[100:103], v[32:47]
    v_mfma_f32_32x32x16_bf16 v[32:47], v[144:147], v[104:107], v[32:47]
    v_mfma_f32_32x32x16_bf16 v[32:47], v[128:131], v[108:111], v[32:47]
    v_add_u32 v6, 57344, v6
    v_add_u32 v5, 57344, v5
    s_nop 6
    ds_write_b128 v10, v[48:51] offset:0
    ds_write_b128 v10, v[52:55] offset:1024
    ds_write_b128 v10, v[56:59] offset:2048
    ds_write_b128 v10, v[60:63] offset:3072
    s_waitcnt lgkmcnt(0)
    s_barrier
    buffer_load_dwordx4 v[112:115], v13, s[56:59], s79 offen offset:0 sc1
    buffer_load_dwordx4 v[116:119], v13, s[56:59], s79 offen offset:1024 sc1
    buffer_load_dwordx4 v[120:123], v13, s[56:59], s79 offen offset:2048 sc1
    buffer_load_dwordx4 v[124:127], v13, s[56:59], s79 offen offset:3072 sc1
    buffer_load_dwordx4 v[64:67], v13, s[56:59], s76 offen offset:0 sc1
    buffer_load_dwordx4 v[68:71], v13, s[56:59], s76 offen offset:1024 sc1
    buffer_load_dwordx4 v[72:75], v13, s[56:59], s76 offen offset:2048 sc1
    buffer_load_dwordx4 v[76:79], v13, s[56:59], s76 offen offset:3072 sc1
    ds_read_b128 v[48:51], v11 offset:0
    ds_read_b128 v[52:55], v11 offset:1024
    ds_read_b128 v[56:59], v11 offset:2048
    ds_read_b128 v[60:63], v11 offset:3072
    s_waitcnt lgkmcnt(3)
    v_add_f32 v32, v32, v48
    v_add_f32 v33, v33, v49
    v_add_f32 v34, v34, v50
    v_add_f32 v35, v35, v51
    v_cvt_pk_bf16_f32 v16, v32, v33
    v_cvt_pk_bf16_f32 v17, v34, v35
    s_waitcnt lgkmcnt(2)
    v_add_f32 v36, v36, v52
    v_add_f32 v37, v37, v53
    v_add_f32 v38, v38, v54
    v_add_f32 v39, v39, v55
    v_cvt_pk_bf16_f32 v18, v36, v37
    v_cvt_pk_bf16_f32 v19, v38, v39
    s_waitcnt lgkmcnt(1)
    v_add_f32 v40, v40, v56
    v_add_f32 v41, v41, v57
    v_add_f32 v42, v42, v58
    v_add_f32 v43, v43, v59
    v_cvt_pk_bf16_f32 v20, v40, v41
    v_cvt_pk_bf16_f32 v21, v42, v43
    s_waitcnt lgkmcnt(0)
    ds_write_b128 v152, v[16:19] offset:0
    v_add_f32 v44, v44, v60
    v_add_f32 v45, v45, v61
    v_add_f32 v46, v46, v62
    v_add_f32 v47, v47, v63
    v_cvt_pk_bf16_f32 v22, v44, v45
    v_cvt_pk_bf16_f32 v23, v46, v47
    ds_write_b128 v153, v[20:23] offset:0
    ds_read_b128 v[16:19], v154 offset:0
    ds_read_b128 v[20:23], v154 offset:1024
    s_waitcnt lgkmcnt(2)
    ds_read_b64_tr_b16 v[128:129], v6 offset:24576
    ds_read_b64_tr_b16 v[130:131], v6 offset:25600
    ds_read_b64_tr_b16 v[132:133], v5 offset:24576
    ds_read_b64_tr_b16 v[134:135], v5 offset:25600
    ds_read_b64_tr_b16 v[136:137], v6 offset:26624
    ds_read_b64_tr_b16 v[138:139], v6 offset:27648
    ds_read_b64_tr_b16 v[140:141], v5 offset:26624
    ds_read_b64_tr_b16 v[142:143], v5 offset:27648
    ds_read_b64_tr_b16 v[144:145], v6 offset:28672
    ds_read_b64_tr_b16 v[146:147], v6 offset:29696
    ds_read_b64_tr_b16 v[148:149], v5 offset:28672
    ds_read_b64_tr_b16 v[150:151], v5 offset:29696
    buffer_load_dwordx4 v[80:83], v13, s[56:59], s77 offen offset:0 sc1
    buffer_load_dwordx4 v[84:87], v13, s[56:59], s77 offen offset:1024 sc1
    buffer_load_dwordx4 v[88:91], v13, s[56:59], s77 offen offset:2048 sc1
    buffer_load_dwordx4 v[92:95], v13, s[56:59], s77 offen offset:3072 sc1
    s_waitcnt vmcnt(8)
    v_max3_u32 v3, v112, v113, v114
    v_max3_u32 v3, v3, v115, v116
    v_max3_u32 v3, v3, v117, v118
    v_max3_u32 v3, v3, v119, v120
    v_max3_u32 v3, v3, v121, v122
    v_max3_u32 v3, v3, v123, v124
    v_max3_u32 v3, v3, v125, v126
    v_max_u32 v3, v3, v127
    v_cmp_eq_u32 vcc, -1, v3
    s_cbranch_vccnz L_retry3
L_ok3:
    s_waitcnt lgkmcnt(8)
    v_mfma_f32_32x32x16_bf16 v[48:63], v[132:135], v[112:115], 0
    v_mfma_f32_32x32x16_bf16 v[32:47], v[128:131], v[112:115], 0
    ds_read_b64_tr_b16 v[128:129], v6 offset:30720
    ds_read_b64_tr_b16 v[130:131], v6 offset:31744
    ds_read_b64_tr_b16 v[132:133], v5 offset:30720
    ds_read_b64_tr_b16 v[134:135], v5 offset:31744
    buffer_load_dwordx4 v[96:99], v13, s[56:59], s78 offen offset:0 sc1
    buffer_load_dwordx4 v[100:103], v13, s[56:59], s78 offen offset:1024 sc1
    buffer_load_dwordx4 v[104:107], v13, s[56:59], s78 offen offset:2048 sc1
    buffer_load_dwordx4 v[108:111], v13, s[56:59], s78 offen offset:3072 sc1
    s_waitcnt lgkmcnt(8)
    v_mfma_f32_32x32x16_bf16 v[48:63], v[140:143], v[116:119], v[48:63]
    v_mfma_f32_32x32x16_bf16 v[32:47], v[136:139], v[116:119], v[32:47]
    ds_read_b64_tr_b16 v[136:137], v6 offset:0
    ds_read_b64_tr_b16 v[138:139], v6 offset:1024
    ds_read_b64_tr_b16 v[140:141], v5 offset:0
    ds_read_b64_tr_b16 v[142:143], v5 offset:1024
    s_waitcnt lgkmcnt(8)
    v_mfma_f32_32x32x16_bf16 v[48:63], v[148:151], v[120:123], v[48:63]
    v_mfma_f32_32x32x16_bf16 v[32:47], v[144:147], v[120:123], v[32:47]
    ds_read_b64_tr_b16 v[144:145], v6 offset:2048
    ds_read_b64_tr_b16 v[146:147], v6 offset:3072
    ds_read_b64_tr_b16 v[148:149], v5 offset:2048
    ds_read_b64_tr_b16 v[150:151], v5 offset:3072
    s_waitcnt vmcnt(8) lgkmcnt(8)
    v_mfma_f32_32x32x16_bf16 v[48:63], v[132:135], v[124:127], v[48:63]
    v_max3_u32 v3, v64, v65, v66
    v_max3_u32 v3, v3, v67, v68
    v_max3_u32 v3, v3, v69, v70
    v_max3_u32 v3, v3, v71, v72
    v_max3_u32 v3, v3, v73, v74
    v_mfma_f32_32x32x16_bf16 v[32:47], v[128:131], v[124:127], v[32:47]
    ds_read_b64_tr_b16 v[128:129], v6 offset:4096
    ds_read_b64_tr_b16 v[130:131], v6 offset:5120
    ds_read_b64_tr_b16 v[132:133], v5 offset:4096
    ds_read_b64_tr_b16 v[134:135], v5 offset:5120
    v_max3_u32 v3, v3, v75, v76
    v_max3_u32 v3, v3, v77, v78
    v_max_u32 v3, v3, v79
    v_cmp_eq_u32 vcc, -1, v3
    s_cbranch_vccnz L_retry0
L_ok0:
    s_waitcnt lgkmcnt(8)
    v_mfma_f32_32x32x16_bf16 v[48:63], v[140:143], v[64:67], v[48:63]
    v_mfma_f32_32x32x16_bf16 v[32:47], v[136:139], v[64:67], v[32:47]
    ds_read_b64_tr_b16 v[136:137], v6 offset:6144
    ds_read_b64_tr_b16 v[138:139], v6 offset:7168
    ds_read_b64_tr_b16 v[140:141], v5 offset:6144
    ds_read_b64_tr_b16 v[142:143], v5 offset:7168
    s_waitcnt lgkmcnt(8)
    v_mfma_f32_32x32x16_bf16 v[48:63], v[148:151], v[68:71], v[48:63]
    v_mfma_f32_32x32x16_bf16 v[32:47], v[144:147], v[68:71], v[32:47]
    ds_read_b64_tr_b16 v[144:145], v6 offset:8192
    ds_read_b64_tr_b16 v[146:147], v6 offset:9216
    ds_read_b64_tr_b16 v[148:149], v5 offset:8192
    ds_read_b64_tr_b16 v[150:151], v5 offset:9216
    s_waitcnt lgkmcnt(8)
    v_mfma_f32_32x32x16_bf16 v[48:63], v[132:135], v[72:75], v[48:63]
    v_mfma_f32_32x32x16_bf16 v[32:47], v[128:131], v[72:75], v[32:47]
    ds_read_b64_tr_b16 v[128:129], v6 offset:10240
    ds_read_b64_tr_b16 v[130:131], v6 offset:11264
    ds_read_b64_tr_b16 v[132:133], v5 offset:10240
    ds_read_b64_tr_b16 v[134:135], v5 offset:11264
    s_waitcnt vmcnt(4) lgkmcnt(8)
    v_mfma_f32_32x32x16_bf16 v[48:63], v[140:143], v[76:79], v[48:63]
    v_max3_u32 v3, v80, v81, v82
    v_max3_u32 v3, v3, v83, v84
    v_max3_u32 v3, v3, v85, v86
    v_max3_u32 v3, v3, v87, v88
    v_max3_u32 v3, v3, v89, v90
    v_mfma_f32_32x32x16_bf16 v[32:47], v[136:139], v[76:79], v[32:47]
    ds_read_b64_tr_b16 v[136:137], v6 offset:12288
    ds_read_b64_tr_b16 v[138:139], v6 offset:13312
    ds_read_b64_tr_b16 v[140:141], v5 offset:12288
    ds_read_b64_tr_b16 v[142:143], v5 offset:13312
    v_max3_u32 v3, v3, v91, v92
    v_max3_u32 v3, v3, v93, v94
    v_max_u32 v3, v3, v95
    v_cmp_eq_u32 vcc, -1, v3
    s_cbranch_vccnz L_retry1
L_ok1:
    s_waitcnt lgkmcnt(8)
    v_mfma_f32_32x32x16_bf16 v[48:63], v[148:151], v[80:83], v[48:63]
    v_mfma_f32_32x32x16_bf16 v[32:47], v[144:147], v[80:83], v[32:47]
    ds_read_b64_tr_b16 v[144:145], v6 offset:14336
    ds_read_b64_tr_b16 v[146:147], v6 offset:15360
    ds_read_b64_tr_b16 v[148:149], v5 offset:14336
    ds_read_b64_tr_b16 v[150:151], v5 offset:15360
    s_waitcnt lgkmcnt(8)
    v_mfma_f32_32x32x16_bf16 v[48:63], v[132:135], v[84:87], v[48:63]
    v_mfma_f32_32x32x16_bf16 v[32:47], v[128:131], v[84:87], v[32:47]
    ds_read_b64_tr_b16 v[128:129], v6 offset:16384
    ds_read_b64_tr_b16 v[130:131], v6 offset:17408
    ds_read_b64_tr_b16 v[132:133], v5 offset:16384
    ds_read_b64_tr_b16 v[134:135], v5 offset:17408
    s_waitcnt lgkmcnt(8)
    v_mfma_f32_32x32x16_bf16 v[48:63], v[140:143], v[88:91], v[48:63]
    v_mfma_f32_32x32x16_bf16 v[32:47], v[136:139], v[88:91], v[32:47]
    ds_read_b64_tr_b16 v[136:137], v6 offset:18432
    ds_read_b64_tr_b16 v[138:139], v6 offset:19456
    ds_read_b64_tr_b16 v[140:141], v5 offset:18432
    ds_read_b64_tr_b16 v[142:143], v5 offset:19456
    s_waitcnt vmcnt(0) lgkmcnt(8)
    v_mfma_f32_32x32x16_bf16 v[48:63], v[148:151], v[92:95], v[48:63]
    v_max3_u32 v3, v96, v97, v98
    v_max3_u32 v3, v3, v99, v100
    v_max3_u32 v3, v3, v101, v102
    v_max3_u32 v3, v3, v103, v104
    v_max3_u32 v3, v3, v105, v106
    v_mfma_f32_32x32x16_bf16 v[32:47], v[144:147], v[92:95], v[32:47]
    ds_read_b64_tr_b16 v[144:145], v6 offset:20480
    ds_read_b64_tr_b16 v[146:147], v6 offset:21504
    ds_read_b64_tr_b16 v[148:149], v5 offset:20480
    ds_read_b64_tr_b16 v[150:151], v5 offset:21504
    v_max3_u32 v3, v3, v107, v108
    v_max3_u32 v3, v3, v109, v110
    v_max_u32 v3, v3, v111
    v_cmp_eq_u32 vcc, -1, v3
    s_cbranch_vccnz L_retry2
L_ok2:
    s_add_u32 s67, s100, 65536
    buffer_store_dwordx4 v[16:19], v7, s[48:51], s100 offen sc1
    buffer_store_dwordx4 v[20:23], v7, s[48:51], s67 offen sc1
    s_waitcnt lgkmcnt(8)
    v_mfma_f32_32x32x16_bf16 v[48:63], v[132:135], v[96:99], v[48:63]
    v_mfma_f32_32x32x16_bf16 v[32:47], v[128:131], v[96:99], v[32:47]
    ds_read_b64_tr_b16 v[128:129], v6 offset:22528
    ds_read_b64_tr_b16 v[130:131], v6 offset:23552
    ds_read_b64_tr_b16 v[132:133], v5 offset:22528
    ds_read_b64_tr_b16 v[134:135], v5 offset:23552
    s_waitcnt lgkmcnt(8)
    v_mfma_f32_32x32x16_bf16 v[48:63], v[140:143], v[100:103], v[48:63]
    s_waitcnt lgkmcnt(4)
    v_mfma_f32_32x32x16_bf16 v[48:63], v[148:151], v[104:107], v[48:63]
    s_waitcnt lgkmcnt(0)
    v_mfma_f32_32x32x16_bf16 v[48:63], v[132:135], v[108:111], v[48:63]
    v_mfma_f32_32x32x16_bf16 v[32:47], v[136:139], v[100:103], v[32:47]
    v_mfma_f32_32x32x16_bf16 v[32:47], v[144:147], v[104:107], v[32:47]
    v_mfma_f32_32x32x16_bf16 v[32:47], v[128:131], v[108:111], v[32:47]
    s_nop 8
    ds_write_b128 v10, v[48:51] offset:16384
    ds_write_b128 v10, v[52:55] offset:17408
    ds_write_b128 v10, v[56:59] offset:18432
    ds_write_b128 v10, v[60:63] offset:19456
    s_waitcnt lgkmcnt(0)
    s_barrier
    ds_read_b128 v[48:51], v11 offset:16384
    ds_read_b128 v[52:55], v11 offset:17408
    ds_read_b128 v[56:59], v11 offset:18432
    ds_read_b128 v[60:63], v11 offset:19456
    s_waitcnt lgkmcnt(3)
    v_add_f32 v32, v32, v48
    v_add_f32 v33, v33, v49
    v_add_f32 v34, v34, v50
    v_add_f32 v35, v35, v51
    v_cvt_pk_bf16_f32 v24, v32, v33
    v_cvt_pk_bf16_f32 v25, v34, v35
    s_waitcnt lgkmcnt(2)
    v_add_f32 v36, v36, v52
    v_add_f32 v37, v37, v53
    v_add_f32 v38, v38, v54
    v_add_f32 v39, v39, v55
    v_cvt_pk_bf16_f32 v26, v36, v37
    v_cvt_pk_bf16_f32 v27, v38, v39
    s_waitcnt lgkmcnt(1)
    v_add_f32 v40, v40, v56
    v_add_f32 v41, v41, v57
    v_add_f32 v42, v42, v58
    v_add_f32 v43, v43, v59
    v_cvt_pk_bf16_f32 v28, v40, v41
    v_cvt_pk_bf16_f32 v29, v42, v43
    s_waitcnt lgkmcnt(0)
    ds_write_b128 v152, v[24:27] offset:16384
    v_add_f32 v44, v44, v60
    v_add_f32 v45, v45, v61
    v_add_f32 v46, v46, v62
    v_add_f32 v47, v47, v63
    v_cvt_pk_bf16_f32 v30, v44, v45
    v_cvt_pk_bf16_f32 v31, v46, v47
    ds_write_b128 v153, v[28:31] offset:16384
    ds_read_b128 v[24:27], v154 offset:16384
    ds_read_b128 v[28:31], v154 offset:17408
    s_waitcnt lgkmcnt(0)
    s_add_u32 s67, s100, 32768
    buffer_store_dwordx4 v[24:27], v9, s[48:51], s100 offen sc1
    buffer_store_dwordx4 v[28:31], v9, s[48:51], s67 offen sc1
L_end:
L_exit:
    s_endpgm
L_retry3:
    s_cmp_eq_u32 s88, 0
    s_cbranch_scc1 L_ok3
    s_sub_u32 s88, s88, 1
    buffer_load_dwordx4 v[112:115], v13, s[56:59], s79 offen offset:0 sc1
    buffer_load_dwordx4 v[116:119], v13, s[56:59], s79 offen offset:1024 sc1
    buffer_load_dwordx4 v[120:123], v13, s[56:59], s79 offen offset:2048 sc1
    buffer_load_dwordx4 v[124:127], v13, s[56:59], s79 offen offset:3072 sc1
    s_waitcnt vmcnt(0)
    v_max3_u32 v3, v112, v113, v114
    v_max3_u32 v3, v3, v115, v116
    v_max3_u32 v3, v3, v117, v118
    v_max3_u32 v3, v3, v119, v120
    v_max3_u32 v3, v3, v121, v122
    v_max3_u32 v3, v3, v123, v124
    v_max3_u32 v3, v3, v125, v126
    v_max_u32 v3, v3, v127
    v_cmp_eq_u32 vcc, -1, v3
    s_cbranch_vccnz L_retry3
    s_branch L_ok3
L_retry0:
    s_cmp_eq_u32 s88, 0
    s_cbranch_scc1 L_ok0
    s_sub_u32 s88, s88, 1
    buffer_load_dwordx4 v[64:67], v13, s[56:59], s76 offen offset:0 sc1
    buffer_load_dwordx4 v[68:71], v13, s[56:59], s76 offen offset:1024 sc1
    buffer_load_dwordx4 v[72:75], v13, s[56:59], s76 offen offset:2048 sc1
    buffer_load_dwordx4 v[76:79], v13, s[56:59], s76 offen offset:3072 sc1
    s_waitcnt vmcnt(0)
    v_max3_u32 v3, v64, v65, v66
    v_max3_u32 v3, v3, v67, v68
    v_max3_u32 v3, v3, v69, v70
    v_max3_u32 v3, v3, v71, v72
    v_max3_u32 v3, v3, v73, v74
    v_max3_u32 v3, v3, v75, v76
    v_max3_u32 v3, v3, v77, v78
    v_max_u32 v3, v3, v79
    v_cmp_eq_u32 vcc, -1, v3
    s_cbranch_vccnz L_retry0
    s_branch L_ok0
L_retry1:
    s_cmp_eq_u32 s88, 0
    s_cbranch_scc1 L_ok1
    s_sub_u32 s88, s88, 1
    buffer_load_dwordx4 v[80:83], v13, s[56:59], s77 offen offset:0 sc1
    buffer_load_dwordx4 v[84:87], v13, s[56:59], s77 offen offset:1024 sc1
    buffer_load_dwordx4 v[88:91], v13, s[56:59], s77 offen offset:2048 sc1
    buffer_load_dwordx4 v[92:95], v13, s[56:59], s77 offen offset:3072 sc1
    s_waitcnt vmcnt(0)
    v_max3_u32 v3, v80, v81, v82
    v_max3_u32 v3, v3, v83, v84
    v_max3_u32 v3, v3, v85, v86
    v_max3_u32 v3, v3, v87, v88
    v_max3_u32 v3, v3, v89, v90
    v_max3_u32 v3, v3, v91, v92
    v_max3_u32 v3, v3, v93, v94
    v_max_u32 v3, v3, v95
    v_cmp_eq_u32 vcc, -1, v3
    s_cbranch_vccnz L_retry1
    s_branch L_ok1
L_retry2:
    s_cmp_eq_u32 s88, 0
    s_cbranch_scc1 L_ok2
    s_sub_u32 s88, s88, 1
    buffer_load_dwordx4 v[96:99], v13, s[56:59], s78 offen offset:0 sc1
    buffer_load_dwordx4 v[100:103], v13, s[56:59], s78 offen offset:1024 sc1
    buffer_load_dwordx4 v[104:107], v13, s[56:59], s78 offen offset:2048 sc1
    buffer_load_dwordx4 v[108:111], v13, s[56:59], s78 offen offset:3072 sc1
    s_waitcnt vmcnt(0)
    v_max3_u32 v3, v96, v97, v98
    v_max3_u32 v3, v3, v99, v100
    v_max3_u32 v3, v3, v101, v102
    v_max3_u32 v3, v3, v103, v104
    v_max3_u32 v3, v3, v105, v106
    v_max3_u32 v3, v3, v107, v108
    v_max3_u32 v3, v3, v109, v110
    v_max_u32 v3, v3, v111
    v_cmp_eq_u32 vcc, -1, v3
    s_cbranch_vccnz L_retry2
    s_branch L_ok2
L_code_end:
.section .rodata,"a"
.p2align 6
.amdhsa_kernel concat_heads__softmax_full_mha__sliding_local_dilated__prompt_kernel
  .amdhsa_next_free_vgpr 168
  .amdhsa_next_free_sgpr 102
  .amdhsa_accum_offset 168
  .amdhsa_group_segment_fixed_size 0
  .amdhsa_kernarg_size 72
  .amdhsa_user_sgpr_count 2
  .amdhsa_user_sgpr_kernarg_segment_ptr 1
  .amdhsa_system_sgpr_workgroup_id_x 1
.end_amdhsa_kernel
```
